```python
import torch

def _softmax(x, axis=-1):
    return torch.softmax(x, dim=axis)
def _gelu(x):
    return torch.nn.functional.gelu(x, approximate="tanh")
def _silu(x):
    return torch.nn.functional.silu(x)
def _sigmoid(x):
    return torch.sigmoid(x)
def _layernorm(x, axis=-1, eps=1e-5):
    m = x.mean(dim=axis, keepdim=True)
    v = x.var(dim=axis, keepdim=True, unbiased=False)
    return (x - m) / torch.sqrt(v + eps)
def _scatter_add(tgt, idx, src, axis=0):
    return tgt.clone().index_add_(axis, idx, src)
def _segment_sum(src, seg, n):
    out = torch.zeros((n,) + src.shape[1:], dtype=src.dtype)
    return out.index_add_(0, seg, src)
def _pad(x, pw):
    flat = tuple(v for pair in reversed(pw) for v in pair)
    return torch.nn.functional.pad(x, flat)

kernel_name = 'concat_heads__softmax_full_mha__sliding_local_dilated__prompt'

def setup_inputs():

    _w = (lambda a: (lambda t: t.to(torch.bfloat16) if t.is_floating_point() else t)(torch.as_tensor(a)))
    def _A_setup():
        B, S, D = 1, 2048, 640
        return {
            "x": _w((lambda *s: torch.randn(*s, dtype=torch.bfloat16) * 0.2)(B, S, D)),
            "wqkv": _w((lambda *s: torch.randn(*s, dtype=torch.bfloat16) * 0.4)(D, 3 * D)),
            "wo": _w((lambda *s: torch.randn(*s, dtype=torch.bfloat16) * 0.1)(D, D)),
        }
    _A_in = _A_setup()

    def _B_setup():
        B, S, D = 1, 2048, 640
        return {
            "x": _w((lambda *s: torch.randn(*s, dtype=torch.bfloat16) * 0.4)(B, S, D)),
            "wqkv": _w((lambda *s: torch.randn(*s, dtype=torch.bfloat16) * 0.4)(D, 3 * D)),
            "wo": _w((lambda *s: torch.randn(*s, dtype=torch.bfloat16) * 0.05)(D, D)),
        }
    _B_in = _B_setup()

    return {
        "A_x": _A_in["x"],
        "A_wqkv": _A_in["wqkv"],
        "A_wo": _A_in["wo"],
        "B_x": _B_in["x"],
        "B_wqkv": _B_in["wqkv"],
        "B_wo": _B_in["wo"],
    }

def reference(A_x, A_wqkv, A_wo, B_x, B_wqkv, B_wo):
    def _A_ref(x, wqkv, wo):
        B, S, D = x.shape
        H = 32; Dh = D // H
        qkv = (lambda x, *d: x.permute(*d))((x @ wqkv).reshape(B, S, 3, H, Dh), 2, 0, 3, 1, 4)
        q, k, v = qkv[0], qkv[1], qkv[2]
        scale = Dh ** -0.5
        scores = torch.einsum("bhqd,bhkd->bhqk", q, k) * scale
        p = _softmax(scores, axis=-1)
        o = torch.einsum("bhqk,bhkd->bhqd", p, v)
        return (lambda x, *d: x.permute(*d))(o, 0, 2, 1, 3).reshape(B, S, D) @ wo

    def _B_ref(x, wqkv, wo):
        B, S, D = x.shape
        H = 32; Dh = D // H
        W, dil = 8, 2
        qkv = (lambda x, *d: x.permute(*d))((x @ wqkv).reshape(B, S, 3, H, Dh), 2, 0, 3, 1, 4)
        q, k, v = qkv[0], qkv[1], qkv[2]
        scale = Dh ** -0.5
        pos = torch.arange(S)
        off = torch.arange(W) * dil
        idx = pos[:, None] - off[None, :]
        mask = idx >= 0
        idx_c = torch.where(mask, idx, 0).reshape(-1)
        kg = k[:, :, idx_c, :].reshape(B, H, S, W, Dh)
        vg = v[:, :, idx_c, :].reshape(B, H, S, W, Dh)
        logits = torch.einsum("bhsd,bhswd->bhsw", q, kg) * scale
        logits = torch.where(mask[None, None, :, :], logits, -1e9)
        attn = _softmax(logits, axis=-1)
        o = torch.einsum("bhsw,bhswd->bhsd", attn, vg)
        return (lambda x, *d: x.permute(*d))(o, 0, 2, 1, 3).reshape(B, S, D) @ wo

    a = _A_ref(A_x, A_wqkv, A_wo)
    b = _B_ref(B_x, B_wqkv, B_wo)
    return torch.concatenate([a, b], axis=-1)
```

```asm
; @launch kernel=k1_qkv_kernel grid=(256,1,1) block=(512,1,1) lds=98304
; @launch kernel=k2_attn_kernel grid=(256,1,1) block=(1024,1,1) lds=151552
; @launch kernel=k3_proj_kernel grid=(256,1,1) block=(512,1,1) lds=122880
.amdgcn_target "amdgcn-amd-amdhsa--gfx950"
.text
    .globl k1_qkv_kernel
    .p2align 8
    .type k1_qkv_kernel,@function
k1_qkv_kernel:
    s_cmp_ge_u32 s2, 256
    s_cbranch_scc1 K1_END
    s_and_b32 s3, s2, 7
    s_lshr_b32 s4, s2, 3
    s_mov_b32 s5, 0
    s_lshr_b32 s6, s3, 1
    s_and_b32 s7, s3, 1
    s_and_b32 s8, s4, 3
    s_lshl_b32 s6, s6, 2
    s_add_u32 s8, s8, s6
    s_lshr_b32 s9, s4, 2
    s_lshl_b32 s7, s7, 3
    s_add_u32 s9, s9, s7
    s_cmp_ge_u32 s9, 15
    s_cbranch_scc1 K1_END
    s_load_dwordx4 s[16:19], s[0:1], 0
    s_load_dwordx2 s[20:21], s[0:1], 64

    v_lshrrev_b32 v1, 6, v0
    v_and_b32 v2, 63, v0
    s_nop 0
    v_readfirstlane_b32 s11, v1

    s_cmp_ge_u32 s11, 4
    s_cbranch_scc0 K1_COMPUTE
    s_sub_u32 s12, s11, 4
    v_lshrrev_b32 v3, 3, v2
    v_mul_u32_u24 v4, 1280, v3
    v_lshrrev_b32 v5, 4, v2
    s_and_b32 s13, s12, 1
    s_lshl_b32 s13, s13, 2
    v_add_u32 v6, s13, v5
    v_and_b32 v7, 7, v2
    v_xor_b32 v7, v7, v6
    v_lshlrev_b32 v7, 4, v7
    v_add_u32 v10, v4, v7
    v_mul_u32_u24 v4, 3840, v5
    v_lshlrev_b32 v6, 2, v5
    v_and_b32 v7, 15, v2
    v_xor_b32 v7, v7, v6
    v_lshlrev_b32 v7, 4, v7
    v_add_u32 v11, v4, v7
    s_lshl_b32 s14, s8, 7
    s_lshl_b32 s15, s12, 3
    s_add_u32 s14, s14, s15
    s_mul_i32 s33, s14, 1280
    s_mul_i32 s34, s12, 15360
    s_lshl_b32 s15, s9, 8
    s_add_u32 s34, s34, s15
    s_lshl_b32 s35, s12, 10

    s_and_b32 s41, s4, 3
    s_lshr_b32 s42, s4, 2
    s_add_u32 s41, s41, s42
    s_lshl_b32 s41, s41, 2
    s_mov_b32 s42, 0x85308530
    s_mov_b32 s43, 0x530
    s_lshr_b64 s[42:43], s[42:43], s41
    s_and_b32 s41, s42, 15

    s_waitcnt lgkmcnt(0)
    s_mov_b32 s24, s16
    s_and_b32 s25, s17, 0xffff
    s_mov_b32 s26, 2621440
    s_mov_b32 s27, 0x20000
    s_mov_b32 s28, s18
    s_and_b32 s29, s19, 0xffff
    s_mov_b32 s30, 2457600
    s_mov_b32 s31, 0x20000
    s_lshl_b32 s39, s41, 7
    s_add_u32 s39, s39, s33
    s_mul_i32 s40, s41, 245760
    s_add_u32 s40, s40, s34
    s_add_u32 s41, s41, 1
    s_cmp_eq_u32 s41, 10
    s_cselect_b32 s41, 0, s41
    s_add_u32 m0, s35, 0
    s_add_u32 s36, s39, 0
    buffer_load_dwordx4 v10, s[24:27], s36 offen lds
    s_add_u32 m0, s35, 16384
    s_add_u32 s36, s40, 0
    buffer_load_dwordx4 v11, s[28:31], s36 offen lds
    s_add_u32 m0, s35, 4096
    s_add_u32 s36, s39, 40960
    buffer_load_dwordx4 v10, s[24:27], s36 offen lds
    s_add_u32 m0, s35, 20480
    s_add_u32 s36, s40, 61440
    buffer_load_dwordx4 v11, s[28:31], s36 offen lds
    s_add_u32 m0, s35, 8192
    s_add_u32 s36, s39, 81920
    buffer_load_dwordx4 v10, s[24:27], s36 offen lds
    s_add_u32 m0, s35, 24576
    s_add_u32 s36, s40, 122880
    buffer_load_dwordx4 v11, s[28:31], s36 offen lds
    s_add_u32 m0, s35, 12288
    s_add_u32 s36, s39, 122880
    buffer_load_dwordx4 v10, s[24:27], s36 offen lds
    s_add_u32 m0, s35, 28672
    s_add_u32 s36, s40, 184320
    buffer_load_dwordx4 v11, s[28:31], s36 offen lds
    s_lshl_b32 s39, s41, 7
    s_add_u32 s39, s39, s33
    s_mul_i32 s40, s41, 245760
    s_add_u32 s40, s40, s34
    s_add_u32 s41, s41, 1
    s_cmp_eq_u32 s41, 10
    s_cselect_b32 s41, 0, s41
    s_add_u32 m0, s35, 32768
    s_add_u32 s36, s39, 0
    buffer_load_dwordx4 v10, s[24:27], s36 offen lds
    s_add_u32 m0, s35, 49152
    s_add_u32 s36, s40, 0
    buffer_load_dwordx4 v11, s[28:31], s36 offen lds
    s_add_u32 m0, s35, 36864
    s_add_u32 s36, s39, 40960
    buffer_load_dwordx4 v10, s[24:27], s36 offen lds
    s_add_u32 m0, s35, 53248
    s_add_u32 s36, s40, 61440
    buffer_load_dwordx4 v11, s[28:31], s36 offen lds
    s_waitcnt vmcnt(4)
    s_barrier
    s_add_u32 m0, s35, 40960
    s_add_u32 s36, s39, 81920
    buffer_load_dwordx4 v10, s[24:27], s36 offen lds
    s_add_u32 m0, s35, 57344
    s_add_u32 s36, s40, 122880
    buffer_load_dwordx4 v11, s[28:31], s36 offen lds
    s_add_u32 m0, s35, 45056
    s_add_u32 s36, s39, 122880
    buffer_load_dwordx4 v10, s[24:27], s36 offen lds
    s_add_u32 m0, s35, 61440
    s_add_u32 s36, s40, 184320
    buffer_load_dwordx4 v11, s[28:31], s36 offen lds
    s_lshl_b32 s39, s41, 7
    s_add_u32 s39, s39, s33
    s_mul_i32 s40, s41, 245760
    s_add_u32 s40, s40, s34
    s_add_u32 s41, s41, 1
    s_cmp_eq_u32 s41, 10
    s_cselect_b32 s41, 0, s41
    s_add_u32 m0, s35, 65536
    s_add_u32 s36, s39, 0
    buffer_load_dwordx4 v10, s[24:27], s36 offen lds
    s_add_u32 m0, s35, 81920
    s_add_u32 s36, s40, 0
    buffer_load_dwordx4 v11, s[28:31], s36 offen lds
    s_add_u32 m0, s35, 69632
    s_add_u32 s36, s39, 40960
    buffer_load_dwordx4 v10, s[24:27], s36 offen lds
    s_add_u32 m0, s35, 86016
    s_add_u32 s36, s40, 61440
    buffer_load_dwordx4 v11, s[28:31], s36 offen lds
    s_add_u32 m0, s35, 73728
    s_add_u32 s36, s39, 81920
    buffer_load_dwordx4 v10, s[24:27], s36 offen lds
    s_add_u32 m0, s35, 90112
    s_add_u32 s36, s40, 122880
    buffer_load_dwordx4 v11, s[28:31], s36 offen lds
    s_add_u32 m0, s35, 77824
    s_add_u32 s36, s39, 122880
    buffer_load_dwordx4 v10, s[24:27], s36 offen lds
    s_add_u32 m0, s35, 94208
    s_add_u32 s36, s40, 184320
    buffer_load_dwordx4 v11, s[28:31], s36 offen lds
    s_waitcnt vmcnt(8)
    s_barrier
    s_lshl_b32 s39, s41, 7
    s_add_u32 s39, s39, s33
    s_mul_i32 s40, s41, 245760
    s_add_u32 s40, s40, s34
    s_add_u32 s41, s41, 1
    s_cmp_eq_u32 s41, 10
    s_cselect_b32 s41, 0, s41
    s_add_u32 m0, s35, 0
    s_add_u32 s36, s39, 0
    buffer_load_dwordx4 v10, s[24:27], s36 offen lds
    s_add_u32 m0, s35, 16384
    s_add_u32 s36, s40, 0
    buffer_load_dwordx4 v11, s[28:31], s36 offen lds
    s_add_u32 m0, s35, 4096
    s_add_u32 s36, s39, 40960
    buffer_load_dwordx4 v10, s[24:27], s36 offen lds
    s_add_u32 m0, s35, 20480
    s_add_u32 s36, s40, 61440
    buffer_load_dwordx4 v11, s[28:31], s36 offen lds
    s_add_u32 m0, s35, 8192
    s_add_u32 s36, s39, 81920
    buffer_load_dwordx4 v10, s[24:27], s36 offen lds
    s_add_u32 m0, s35, 24576
    s_add_u32 s36, s40, 122880
    buffer_load_dwordx4 v11, s[28:31], s36 offen lds
    s_add_u32 m0, s35, 12288
    s_add_u32 s36, s39, 122880
    buffer_load_dwordx4 v10, s[24:27], s36 offen lds
    s_add_u32 m0, s35, 28672
    s_add_u32 s36, s40, 184320
    buffer_load_dwordx4 v11, s[28:31], s36 offen lds
    s_waitcnt vmcnt(8)
    s_barrier
    s_lshl_b32 s39, s41, 7
    s_add_u32 s39, s39, s33
    s_mul_i32 s40, s41, 245760
    s_add_u32 s40, s40, s34
    s_add_u32 s41, s41, 1
    s_cmp_eq_u32 s41, 10
    s_cselect_b32 s41, 0, s41
    s_add_u32 m0, s35, 32768
    s_add_u32 s36, s39, 0
    buffer_load_dwordx4 v10, s[24:27], s36 offen lds
    s_add_u32 m0, s35, 49152
    s_add_u32 s36, s40, 0
    buffer_load_dwordx4 v11, s[28:31], s36 offen lds
    s_add_u32 m0, s35, 36864
    s_add_u32 s36, s39, 40960
    buffer_load_dwordx4 v10, s[24:27], s36 offen lds
    s_add_u32 m0, s35, 53248
    s_add_u32 s36, s40, 61440
    buffer_load_dwordx4 v11, s[28:31], s36 offen lds
    s_add_u32 m0, s35, 40960
    s_add_u32 s36, s39, 81920
    buffer_load_dwordx4 v10, s[24:27], s36 offen lds
    s_add_u32 m0, s35, 57344
    s_add_u32 s36, s40, 122880
    buffer_load_dwordx4 v11, s[28:31], s36 offen lds
    s_add_u32 m0, s35, 45056
    s_add_u32 s36, s39, 122880
    buffer_load_dwordx4 v10, s[24:27], s36 offen lds
    s_add_u32 m0, s35, 61440
    s_add_u32 s36, s40, 184320
    buffer_load_dwordx4 v11, s[28:31], s36 offen lds
    s_waitcnt vmcnt(8)
    s_barrier
    s_lshl_b32 s39, s41, 7
    s_add_u32 s39, s39, s33
    s_mul_i32 s40, s41, 245760
    s_add_u32 s40, s40, s34
    s_add_u32 s41, s41, 1
    s_cmp_eq_u32 s41, 10
    s_cselect_b32 s41, 0, s41
    s_add_u32 m0, s35, 65536
    s_add_u32 s36, s39, 0
    buffer_load_dwordx4 v10, s[24:27], s36 offen lds
    s_add_u32 m0, s35, 81920
    s_add_u32 s36, s40, 0
    buffer_load_dwordx4 v11, s[28:31], s36 offen lds
    s_add_u32 m0, s35, 69632
    s_add_u32 s36, s39, 40960
    buffer_load_dwordx4 v10, s[24:27], s36 offen lds
    s_add_u32 m0, s35, 86016
    s_add_u32 s36, s40, 61440
    buffer_load_dwordx4 v11, s[28:31], s36 offen lds
    s_add_u32 m0, s35, 73728
    s_add_u32 s36, s39, 81920
    buffer_load_dwordx4 v10, s[24:27], s36 offen lds
    s_add_u32 m0, s35, 90112
    s_add_u32 s36, s40, 122880
    buffer_load_dwordx4 v11, s[28:31], s36 offen lds
    s_add_u32 m0, s35, 77824
    s_add_u32 s36, s39, 122880
    buffer_load_dwordx4 v10, s[24:27], s36 offen lds
    s_add_u32 m0, s35, 94208
    s_add_u32 s36, s40, 184320
    buffer_load_dwordx4 v11, s[28:31], s36 offen lds
    s_waitcnt vmcnt(8)
    s_barrier
    s_lshl_b32 s39, s41, 7
    s_add_u32 s39, s39, s33
    s_mul_i32 s40, s41, 245760
    s_add_u32 s40, s40, s34
    s_add_u32 s41, s41, 1
    s_cmp_eq_u32 s41, 10
    s_cselect_b32 s41, 0, s41
    s_add_u32 m0, s35, 0
    s_add_u32 s36, s39, 0
    buffer_load_dwordx4 v10, s[24:27], s36 offen lds
    s_add_u32 m0, s35, 16384
    s_add_u32 s36, s40, 0
    buffer_load_dwordx4 v11, s[28:31], s36 offen lds
    s_add_u32 m0, s35, 4096
    s_add_u32 s36, s39, 40960
    buffer_load_dwordx4 v10, s[24:27], s36 offen lds
    s_add_u32 m0, s35, 20480
    s_add_u32 s36, s40, 61440
    buffer_load_dwordx4 v11, s[28:31], s36 offen lds
    s_add_u32 m0, s35, 8192
    s_add_u32 s36, s39, 81920
    buffer_load_dwordx4 v10, s[24:27], s36 offen lds
    s_add_u32 m0, s35, 24576
    s_add_u32 s36, s40, 122880
    buffer_load_dwordx4 v11, s[28:31], s36 offen lds
    s_add_u32 m0, s35, 12288
    s_add_u32 s36, s39, 122880
    buffer_load_dwordx4 v10, s[24:27], s36 offen lds
    s_add_u32 m0, s35, 28672
    s_add_u32 s36, s40, 184320
    buffer_load_dwordx4 v11, s[28:31], s36 offen lds
    s_waitcnt vmcnt(8)
    s_barrier
    s_lshl_b32 s39, s41, 7
    s_add_u32 s39, s39, s33
    s_mul_i32 s40, s41, 245760
    s_add_u32 s40, s40, s34
    s_add_u32 s41, s41, 1
    s_cmp_eq_u32 s41, 10
    s_cselect_b32 s41, 0, s41
    s_add_u32 m0, s35, 32768
    s_add_u32 s36, s39, 0
    buffer_load_dwordx4 v10, s[24:27], s36 offen lds
    s_add_u32 m0, s35, 49152
    s_add_u32 s36, s40, 0
    buffer_load_dwordx4 v11, s[28:31], s36 offen lds
    s_add_u32 m0, s35, 36864
    s_add_u32 s36, s39, 40960
    buffer_load_dwordx4 v10, s[24:27], s36 offen lds
    s_add_u32 m0, s35, 53248
    s_add_u32 s36, s40, 61440
    buffer_load_dwordx4 v11, s[28:31], s36 offen lds
    s_add_u32 m0, s35, 40960
    s_add_u32 s36, s39, 81920
    buffer_load_dwordx4 v10, s[24:27], s36 offen lds
    s_add_u32 m0, s35, 57344
    s_add_u32 s36, s40, 122880
    buffer_load_dwordx4 v11, s[28:31], s36 offen lds
    s_add_u32 m0, s35, 45056
    s_add_u32 s36, s39, 122880
    buffer_load_dwordx4 v10, s[24:27], s36 offen lds
    s_add_u32 m0, s35, 61440
    s_add_u32 s36, s40, 184320
    buffer_load_dwordx4 v11, s[28:31], s36 offen lds
    s_waitcnt vmcnt(8)
    s_barrier
    s_lshl_b32 s39, s41, 7
    s_add_u32 s39, s39, s33
    s_mul_i32 s40, s41, 245760
    s_add_u32 s40, s40, s34
    s_add_u32 s41, s41, 1
    s_cmp_eq_u32 s41, 10
    s_cselect_b32 s41, 0, s41
    s_add_u32 m0, s35, 65536
    s_add_u32 s36, s39, 0
    buffer_load_dwordx4 v10, s[24:27], s36 offen lds
    s_add_u32 m0, s35, 81920
    s_add_u32 s36, s40, 0
    buffer_load_dwordx4 v11, s[28:31], s36 offen lds
    s_add_u32 m0, s35, 69632
    s_add_u32 s36, s39, 40960
    buffer_load_dwordx4 v10, s[24:27], s36 offen lds
    s_add_u32 m0, s35, 86016
    s_add_u32 s36, s40, 61440
    buffer_load_dwordx4 v11, s[28:31], s36 offen lds
    s_add_u32 m0, s35, 73728
    s_add_u32 s36, s39, 81920
    buffer_load_dwordx4 v10, s[24:27], s36 offen lds
    s_add_u32 m0, s35, 90112
    s_add_u32 s36, s40, 122880
    buffer_load_dwordx4 v11, s[28:31], s36 offen lds
    s_add_u32 m0, s35, 77824
    s_add_u32 s36, s39, 122880
    buffer_load_dwordx4 v10, s[24:27], s36 offen lds
    s_add_u32 m0, s35, 94208
    s_add_u32 s36, s40, 184320
    buffer_load_dwordx4 v11, s[28:31], s36 offen lds
    s_waitcnt vmcnt(8)
    s_barrier
    s_lshl_b32 s39, s41, 7
    s_add_u32 s39, s39, s33
    s_mul_i32 s40, s41, 245760
    s_add_u32 s40, s40, s34
    s_add_u32 s41, s41, 1
    s_cmp_eq_u32 s41, 10
    s_cselect_b32 s41, 0, s41
    s_add_u32 m0, s35, 0
    s_add_u32 s36, s39, 0
    buffer_load_dwordx4 v10, s[24:27], s36 offen lds
    s_add_u32 m0, s35, 16384
    s_add_u32 s36, s40, 0
    buffer_load_dwordx4 v11, s[28:31], s36 offen lds
    s_add_u32 m0, s35, 4096
    s_add_u32 s36, s39, 40960
    buffer_load_dwordx4 v10, s[24:27], s36 offen lds
    s_add_u32 m0, s35, 20480
    s_add_u32 s36, s40, 61440
    buffer_load_dwordx4 v11, s[28:31], s36 offen lds
    s_add_u32 m0, s35, 8192
    s_add_u32 s36, s39, 81920
    buffer_load_dwordx4 v10, s[24:27], s36 offen lds
    s_add_u32 m0, s35, 24576
    s_add_u32 s36, s40, 122880
    buffer_load_dwordx4 v11, s[28:31], s36 offen lds
    s_add_u32 m0, s35, 12288
    s_add_u32 s36, s39, 122880
    buffer_load_dwordx4 v10, s[24:27], s36 offen lds
    s_add_u32 m0, s35, 28672
    s_add_u32 s36, s40, 184320
    buffer_load_dwordx4 v11, s[28:31], s36 offen lds
    s_waitcnt vmcnt(8)
    s_barrier
    s_waitcnt vmcnt(0)
    s_barrier
    s_endpgm
K1_COMPUTE:
    s_waitcnt lgkmcnt(0)
    s_mov_b32 s24, s16
    s_and_b32 s25, s17, 0xffff
    s_mov_b32 s26, 2621440
    s_mov_b32 s27, 0x20000
    s_mov_b32 s28, s18
    s_and_b32 s29, s19, 0xffff
    s_mov_b32 s30, 2457600
    s_mov_b32 s31, 0x20000
    v_mov_b32 v188, v2
    s_lshr_b32 s12, s11, 1
    s_and_b32 s13, s11, 1
    v_and_b32 v3, 31, v2
    v_lshrrev_b32 v4, 5, v2
    s_lshl_b32 s14, s12, 6
    v_add_u32 v5, s14, v3
    v_lshlrev_b32 v5, 7, v5
    v_bfe_u32 v6, v3, 1, 3

    v_add_u32 v7, 0, v4
    v_xor_b32 v7, v7, v6
    v_lshlrev_b32 v7, 4, v7
    v_add_u32 v176, v5, v7
    v_add_u32 v180, 65536, v176
    v_add_u32 v7, 2, v4
    v_xor_b32 v7, v7, v6
    v_lshlrev_b32 v7, 4, v7
    v_add_u32 v177, v5, v7
    v_add_u32 v181, 65536, v177
    v_add_u32 v7, 4, v4
    v_xor_b32 v7, v7, v6
    v_lshlrev_b32 v7, 4, v7
    v_add_u32 v178, v5, v7
    v_add_u32 v182, 65536, v178
    v_add_u32 v7, 6, v4
    v_xor_b32 v7, v7, v6
    v_lshlrev_b32 v7, 4, v7
    v_add_u32 v179, v5, v7
    v_add_u32 v183, 65536, v179
    v_and_b32 v5, 15, v2
    v_lshrrev_b32 v6, 2, v5
    v_lshlrev_b32 v7, 3, v4
    v_add_u32 v7, v7, v6
    v_lshlrev_b32 v7, 8, v7
    v_bfe_u32 v8, v2, 4, 1
    v_lshlrev_b32 v8, 5, v8
    v_add_u32 v7, v7, v8
    v_and_b32 v8, 3, v5
    v_lshlrev_b32 v8, 3, v8
    v_add_u32 v7, v7, v8
    v_add_u32 v7, 16384, v7
    s_lshl_b32 s14, s13, 1

    s_add_u32 s15, s14, 0
    v_xor_b32 v8, s15, v6
    v_lshlrev_b32 v8, 6, v8
    v_add_u32 v184, v7, v8
    v_add_u32 v186, 65536, v184
    s_add_u32 s15, s14, 1
    v_xor_b32 v8, s15, v6
    v_lshlrev_b32 v8, 6, v8
    v_add_u32 v185, v7, v8
    v_add_u32 v187, 65536, v185
    v_mov_b32 v0, 0
    v_mov_b32 v1, 0
    v_mov_b32 v2, 0
    v_mov_b32 v3, 0
    v_mov_b32 v4, 0
    v_mov_b32 v5, 0
    v_mov_b32 v6, 0
    v_mov_b32 v7, 0
    v_mov_b32 v8, 0
    v_mov_b32 v9, 0
    v_mov_b32 v10, 0
    v_mov_b32 v11, 0
    v_mov_b32 v12, 0
    v_mov_b32 v13, 0
    v_mov_b32 v14, 0
    v_mov_b32 v15, 0
    v_mov_b32 v16, 0
    v_mov_b32 v17, 0
    v_mov_b32 v18, 0
    v_mov_b32 v19, 0
    v_mov_b32 v20, 0
    v_mov_b32 v21, 0
    v_mov_b32 v22, 0
    v_mov_b32 v23, 0
    v_mov_b32 v24, 0
    v_mov_b32 v25, 0
    v_mov_b32 v26, 0
    v_mov_b32 v27, 0
    v_mov_b32 v28, 0
    v_mov_b32 v29, 0
    v_mov_b32 v30, 0
    v_mov_b32 v31, 0
    v_mov_b32 v32, 0
    v_mov_b32 v33, 0
    v_mov_b32 v34, 0
    v_mov_b32 v35, 0
    v_mov_b32 v36, 0
    v_mov_b32 v37, 0
    v_mov_b32 v38, 0
    v_mov_b32 v39, 0
    v_mov_b32 v40, 0
    v_mov_b32 v41, 0
    v_mov_b32 v42, 0
    v_mov_b32 v43, 0
    v_mov_b32 v44, 0
    v_mov_b32 v45, 0
    v_mov_b32 v46, 0
    v_mov_b32 v47, 0
    v_mov_b32 v48, 0
    v_mov_b32 v49, 0
    v_mov_b32 v50, 0
    v_mov_b32 v51, 0
    v_mov_b32 v52, 0
    v_mov_b32 v53, 0
    v_mov_b32 v54, 0
    v_mov_b32 v55, 0
    v_mov_b32 v56, 0
    v_mov_b32 v57, 0
    v_mov_b32 v58, 0
    v_mov_b32 v59, 0
    v_mov_b32 v60, 0
    v_mov_b32 v61, 0
    v_mov_b32 v62, 0
    v_mov_b32 v63, 0
    s_cmp_ge_u32 s9, 10
    s_cbranch_scc1 K1_VTILE
    s_barrier
    ds_read_b64_tr_b16 v[144:145], v184 offset:0
    ds_read_b64_tr_b16 v[146:147], v184 offset:1024
    ds_read_b64_tr_b16 v[148:149], v185 offset:0
    ds_read_b64_tr_b16 v[150:151], v185 offset:1024
    ds_read_b128 v[128:131], v176 offset:0
    ds_read_b128 v[132:135], v176 offset:4096
    s_waitcnt lgkmcnt(0)
    v_mfma_f32_32x32x16_bf16 v[0:15], v[144:147], v[128:131], v[0:15]
    ds_read_b64_tr_b16 v[168:169], v184 offset:4096
    ds_read_b64_tr_b16 v[170:171], v184 offset:5120
    ds_read_b128 v[152:155], v177 offset:0
    v_mfma_f32_32x32x16_bf16 v[16:31], v[148:151], v[128:131], v[16:31]
    ds_read_b64_tr_b16 v[172:173], v185 offset:4096
    ds_read_b64_tr_b16 v[174:175], v185 offset:5120
    ds_read_b128 v[156:159], v177 offset:4096
    v_mfma_f32_32x32x16_bf16 v[32:47], v[144:147], v[132:135], v[32:47]
    v_mfma_f32_32x32x16_bf16 v[48:63], v[148:151], v[132:135], v[48:63]
    s_waitcnt lgkmcnt(0)
    v_mfma_f32_32x32x16_bf16 v[0:15], v[168:171], v[152:155], v[0:15]
    ds_read_b64_tr_b16 v[144:145], v184 offset:8192
    ds_read_b64_tr_b16 v[146:147], v184 offset:9216
    ds_read_b128 v[128:131], v178 offset:0
    v_mfma_f32_32x32x16_bf16 v[16:31], v[172:175], v[152:155], v[16:31]
    ds_read_b64_tr_b16 v[148:149], v185 offset:8192
    ds_read_b64_tr_b16 v[150:151], v185 offset:9216
    ds_read_b128 v[132:135], v178 offset:4096
    v_mfma_f32_32x32x16_bf16 v[32:47], v[168:171], v[156:159], v[32:47]
    v_mfma_f32_32x32x16_bf16 v[48:63], v[172:175], v[156:159], v[48:63]
    s_waitcnt lgkmcnt(0)
    v_mfma_f32_32x32x16_bf16 v[0:15], v[144:147], v[128:131], v[0:15]
    ds_read_b64_tr_b16 v[168:169], v184 offset:12288
    ds_read_b64_tr_b16 v[170:171], v184 offset:13312
    ds_read_b128 v[152:155], v179 offset:0
    v_mfma_f32_32x32x16_bf16 v[16:31], v[148:151], v[128:131], v[16:31]
    ds_read_b64_tr_b16 v[172:173], v185 offset:12288
    ds_read_b64_tr_b16 v[174:175], v185 offset:13312
    ds_read_b128 v[156:159], v179 offset:4096
    v_mfma_f32_32x32x16_bf16 v[32:47], v[144:147], v[132:135], v[32:47]
    v_mfma_f32_32x32x16_bf16 v[48:63], v[148:151], v[132:135], v[48:63]
    s_waitcnt lgkmcnt(0)
    s_barrier
    v_mfma_f32_32x32x16_bf16 v[0:15], v[168:171], v[152:155], v[0:15]
    ds_read_b64_tr_b16 v[144:145], v184 offset:32768
    ds_read_b64_tr_b16 v[146:147], v184 offset:33792
    ds_read_b128 v[128:131], v176 offset:32768
    v_mfma_f32_32x32x16_bf16 v[16:31], v[172:175], v[152:155], v[16:31]
    ds_read_b64_tr_b16 v[148:149], v185 offset:32768
    ds_read_b64_tr_b16 v[150:151], v185 offset:33792
    ds_read_b128 v[132:135], v176 offset:36864
    v_mfma_f32_32x32x16_bf16 v[32:47], v[168:171], v[156:159], v[32:47]
    v_mfma_f32_32x32x16_bf16 v[48:63], v[172:175], v[156:159], v[48:63]
    s_waitcnt lgkmcnt(0)
    v_mfma_f32_32x32x16_bf16 v[0:15], v[144:147], v[128:131], v[0:15]
    ds_read_b64_tr_b16 v[168:169], v184 offset:36864
    ds_read_b64_tr_b16 v[170:171], v184 offset:37888
    ds_read_b128 v[152:155], v177 offset:32768
    v_mfma_f32_32x32x16_bf16 v[16:31], v[148:151], v[128:131], v[16:31]
    ds_read_b64_tr_b16 v[172:173], v185 offset:36864
    ds_read_b64_tr_b16 v[174:175], v185 offset:37888
    ds_read_b128 v[156:159], v177 offset:36864
    v_mfma_f32_32x32x16_bf16 v[32:47], v[144:147], v[132:135], v[32:47]
    v_mfma_f32_32x32x16_bf16 v[48:63], v[148:151], v[132:135], v[48:63]
    s_waitcnt lgkmcnt(0)
    v_mfma_f32_32x32x16_bf16 v[0:15], v[168:171], v[152:155], v[0:15]
    ds_read_b64_tr_b16 v[144:145], v184 offset:40960
    ds_read_b64_tr_b16 v[146:147], v184 offset:41984
    ds_read_b128 v[128:131], v178 offset:32768
    v_mfma_f32_32x32x16_bf16 v[16:31], v[172:175], v[152:155], v[16:31]
    ds_read_b64_tr_b16 v[148:149], v185 offset:40960
    ds_read_b64_tr_b16 v[150:151], v185 offset:41984
    ds_read_b128 v[132:135], v178 offset:36864
    v_mfma_f32_32x32x16_bf16 v[32:47], v[168:171], v[156:159], v[32:47]
    v_mfma_f32_32x32x16_bf16 v[48:63], v[172:175], v[156:159], v[48:63]
    s_waitcnt lgkmcnt(0)
    v_mfma_f32_32x32x16_bf16 v[0:15], v[144:147], v[128:131], v[0:15]
    ds_read_b64_tr_b16 v[168:169], v184 offset:45056
    ds_read_b64_tr_b16 v[170:171], v184 offset:46080
    ds_read_b128 v[152:155], v179 offset:32768
    v_mfma_f32_32x32x16_bf16 v[16:31], v[148:151], v[128:131], v[16:31]
    ds_read_b64_tr_b16 v[172:173], v185 offset:45056
    ds_read_b64_tr_b16 v[174:175], v185 offset:46080
    ds_read_b128 v[156:159], v179 offset:36864
    v_mfma_f32_32x32x16_bf16 v[32:47], v[144:147], v[132:135], v[32:47]
    v_mfma_f32_32x32x16_bf16 v[48:63], v[148:151], v[132:135], v[48:63]
    s_waitcnt lgkmcnt(0)
    s_barrier
    v_mfma_f32_32x32x16_bf16 v[0:15], v[168:171], v[152:155], v[0:15]
    ds_read_b64_tr_b16 v[144:145], v186 offset:0
    ds_read_b64_tr_b16 v[146:147], v186 offset:1024
    ds_read_b128 v[128:131], v180 offset:0
    v_mfma_f32_32x32x16_bf16 v[16:31], v[172:175], v[152:155], v[16:31]
    ds_read_b64_tr_b16 v[148:149], v187 offset:0
    ds_read_b64_tr_b16 v[150:151], v187 offset:1024
    ds_read_b128 v[132:135], v180 offset:4096
    v_mfma_f32_32x32x16_bf16 v[32:47], v[168:171], v[156:159], v[32:47]
    v_mfma_f32_32x32x16_bf16 v[48:63], v[172:175], v[156:159], v[48:63]
    s_waitcnt lgkmcnt(0)
    v_mfma_f32_32x32x16_bf16 v[0:15], v[144:147], v[128:131], v[0:15]
    ds_read_b64_tr_b16 v[168:169], v186 offset:4096
    ds_read_b64_tr_b16 v[170:171], v186 offset:5120
    ds_read_b128 v[152:155], v181 offset:0
    v_mfma_f32_32x32x16_bf16 v[16:31], v[148:151], v[128:131], v[16:31]
    ds_read_b64_tr_b16 v[172:173], v187 offset:4096
    ds_read_b64_tr_b16 v[174:175], v187 offset:5120
    ds_read_b128 v[156:159], v181 offset:4096
    v_mfma_f32_32x32x16_bf16 v[32:47], v[144:147], v[132:135], v[32:47]
    v_mfma_f32_32x32x16_bf16 v[48:63], v[148:151], v[132:135], v[48:63]
    s_waitcnt lgkmcnt(0)
    v_mfma_f32_32x32x16_bf16 v[0:15], v[168:171], v[152:155], v[0:15]
    ds_read_b64_tr_b16 v[144:145], v186 offset:8192
    ds_read_b64_tr_b16 v[146:147], v186 offset:9216
    ds_read_b128 v[128:131], v182 offset:0
    v_mfma_f32_32x32x16_bf16 v[16:31], v[172:175], v[152:155], v[16:31]
    ds_read_b64_tr_b16 v[148:149], v187 offset:8192
    ds_read_b64_tr_b16 v[150:151], v187 offset:9216
    ds_read_b128 v[132:135], v182 offset:4096
    v_mfma_f32_32x32x16_bf16 v[32:47], v[168:171], v[156:159], v[32:47]
    v_mfma_f32_32x32x16_bf16 v[48:63], v[172:175], v[156:159], v[48:63]
    s_waitcnt lgkmcnt(0)
    v_mfma_f32_32x32x16_bf16 v[0:15], v[144:147], v[128:131], v[0:15]
    ds_read_b64_tr_b16 v[168:169], v186 offset:12288
    ds_read_b64_tr_b16 v[170:171], v186 offset:13312
    ds_read_b128 v[152:155], v183 offset:0
    v_mfma_f32_32x32x16_bf16 v[16:31], v[148:151], v[128:131], v[16:31]
    ds_read_b64_tr_b16 v[172:173], v187 offset:12288
    ds_read_b64_tr_b16 v[174:175], v187 offset:13312
    ds_read_b128 v[156:159], v183 offset:4096
    v_mfma_f32_32x32x16_bf16 v[32:47], v[144:147], v[132:135], v[32:47]
    v_mfma_f32_32x32x16_bf16 v[48:63], v[148:151], v[132:135], v[48:63]
    s_waitcnt lgkmcnt(0)
    s_barrier
    v_mfma_f32_32x32x16_bf16 v[0:15], v[168:171], v[152:155], v[0:15]
    ds_read_b64_tr_b16 v[144:145], v184 offset:0
    ds_read_b64_tr_b16 v[146:147], v184 offset:1024
    ds_read_b128 v[128:131], v176 offset:0
    v_mfma_f32_32x32x16_bf16 v[16:31], v[172:175], v[152:155], v[16:31]
    ds_read_b64_tr_b16 v[148:149], v185 offset:0
    ds_read_b64_tr_b16 v[150:151], v185 offset:1024
    ds_read_b128 v[132:135], v176 offset:4096
    v_mfma_f32_32x32x16_bf16 v[32:47], v[168:171], v[156:159], v[32:47]
    v_mfma_f32_32x32x16_bf16 v[48:63], v[172:175], v[156:159], v[48:63]
    s_waitcnt lgkmcnt(0)
    v_mfma_f32_32x32x16_bf16 v[0:15], v[144:147], v[128:131], v[0:15]
    ds_read_b64_tr_b16 v[168:169], v184 offset:4096
    ds_read_b64_tr_b16 v[170:171], v184 offset:5120
    ds_read_b128 v[152:155], v177 offset:0
    v_mfma_f32_32x32x16_bf16 v[16:31], v[148:151], v[128:131], v[16:31]
    ds_read_b64_tr_b16 v[172:173], v185 offset:4096
    ds_read_b64_tr_b16 v[174:175], v185 offset:5120
    ds_read_b128 v[156:159], v177 offset:4096
    v_mfma_f32_32x32x16_bf16 v[32:47], v[144:147], v[132:135], v[32:47]
    v_mfma_f32_32x32x16_bf16 v[48:63], v[148:151], v[132:135], v[48:63]
    s_waitcnt lgkmcnt(0)
    v_mfma_f32_32x32x16_bf16 v[0:15], v[168:171], v[152:155], v[0:15]
    ds_read_b64_tr_b16 v[144:145], v184 offset:8192
    ds_read_b64_tr_b16 v[146:147], v184 offset:9216
    ds_read_b128 v[128:131], v178 offset:0
    v_mfma_f32_32x32x16_bf16 v[16:31], v[172:175], v[152:155], v[16:31]
    ds_read_b64_tr_b16 v[148:149], v185 offset:8192
    ds_read_b64_tr_b16 v[150:151], v185 offset:9216
    ds_read_b128 v[132:135], v178 offset:4096
    v_mfma_f32_32x32x16_bf16 v[32:47], v[168:171], v[156:159], v[32:47]
    v_mfma_f32_32x32x16_bf16 v[48:63], v[172:175], v[156:159], v[48:63]
    s_waitcnt lgkmcnt(0)
    v_mfma_f32_32x32x16_bf16 v[0:15], v[144:147], v[128:131], v[0:15]
    ds_read_b64_tr_b16 v[168:169], v184 offset:12288
    ds_read_b64_tr_b16 v[170:171], v184 offset:13312
    ds_read_b128 v[152:155], v179 offset:0
    v_mfma_f32_32x32x16_bf16 v[16:31], v[148:151], v[128:131], v[16:31]
    ds_read_b64_tr_b16 v[172:173], v185 offset:12288
    ds_read_b64_tr_b16 v[174:175], v185 offset:13312
    ds_read_b128 v[156:159], v179 offset:4096
    v_mfma_f32_32x32x16_bf16 v[32:47], v[144:147], v[132:135], v[32:47]
    v_mfma_f32_32x32x16_bf16 v[48:63], v[148:151], v[132:135], v[48:63]
    s_waitcnt lgkmcnt(0)
    s_barrier
    v_mfma_f32_32x32x16_bf16 v[0:15], v[168:171], v[152:155], v[0:15]
    ds_read_b64_tr_b16 v[144:145], v184 offset:32768
    ds_read_b64_tr_b16 v[146:147], v184 offset:33792
    ds_read_b128 v[128:131], v176 offset:32768
    v_mfma_f32_32x32x16_bf16 v[16:31], v[172:175], v[152:155], v[16:31]
    ds_read_b64_tr_b16 v[148:149], v185 offset:32768
    ds_read_b64_tr_b16 v[150:151], v185 offset:33792
    ds_read_b128 v[132:135], v176 offset:36864
    v_mfma_f32_32x32x16_bf16 v[32:47], v[168:171], v[156:159], v[32:47]
    v_mfma_f32_32x32x16_bf16 v[48:63], v[172:175], v[156:159], v[48:63]
    s_waitcnt lgkmcnt(0)
    v_mfma_f32_32x32x16_bf16 v[0:15], v[144:147], v[128:131], v[0:15]
    ds_read_b64_tr_b16 v[168:169], v184 offset:36864
    ds_read_b64_tr_b16 v[170:171], v184 offset:37888
    ds_read_b128 v[152:155], v177 offset:32768
    v_mfma_f32_32x32x16_bf16 v[16:31], v[148:151], v[128:131], v[16:31]
    ds_read_b64_tr_b16 v[172:173], v185 offset:36864
    ds_read_b64_tr_b16 v[174:175], v185 offset:37888
    ds_read_b128 v[156:159], v177 offset:36864
    v_mfma_f32_32x32x16_bf16 v[32:47], v[144:147], v[132:135], v[32:47]
    v_mfma_f32_32x32x16_bf16 v[48:63], v[148:151], v[132:135], v[48:63]
    s_waitcnt lgkmcnt(0)
    v_mfma_f32_32x32x16_bf16 v[0:15], v[168:171], v[152:155], v[0:15]
    ds_read_b64_tr_b16 v[144:145], v184 offset:40960
    ds_read_b64_tr_b16 v[146:147], v184 offset:41984
    ds_read_b128 v[128:131], v178 offset:32768
    v_mfma_f32_32x32x16_bf16 v[16:31], v[172:175], v[152:155], v[16:31]
    ds_read_b64_tr_b16 v[148:149], v185 offset:40960
    ds_read_b64_tr_b16 v[150:151], v185 offset:41984
    ds_read_b128 v[132:135], v178 offset:36864
    v_mfma_f32_32x32x16_bf16 v[32:47], v[168:171], v[156:159], v[32:47]
    v_mfma_f32_32x32x16_bf16 v[48:63], v[172:175], v[156:159], v[48:63]
    s_waitcnt lgkmcnt(0)
    v_mfma_f32_32x32x16_bf16 v[0:15], v[144:147], v[128:131], v[0:15]
    ds_read_b64_tr_b16 v[168:169], v184 offset:45056
    ds_read_b64_tr_b16 v[170:171], v184 offset:46080
    ds_read_b128 v[152:155], v179 offset:32768
    v_mfma_f32_32x32x16_bf16 v[16:31], v[148:151], v[128:131], v[16:31]
    ds_read_b64_tr_b16 v[172:173], v185 offset:45056
    ds_read_b64_tr_b16 v[174:175], v185 offset:46080
    ds_read_b128 v[156:159], v179 offset:36864
    v_mfma_f32_32x32x16_bf16 v[32:47], v[144:147], v[132:135], v[32:47]
    v_mfma_f32_32x32x16_bf16 v[48:63], v[148:151], v[132:135], v[48:63]
    s_waitcnt lgkmcnt(0)
    s_barrier
    v_mfma_f32_32x32x16_bf16 v[0:15], v[168:171], v[152:155], v[0:15]
    ds_read_b64_tr_b16 v[144:145], v186 offset:0
    ds_read_b64_tr_b16 v[146:147], v186 offset:1024
    ds_read_b128 v[128:131], v180 offset:0
    v_mfma_f32_32x32x16_bf16 v[16:31], v[172:175], v[152:155], v[16:31]
    ds_read_b64_tr_b16 v[148:149], v187 offset:0
    ds_read_b64_tr_b16 v[150:151], v187 offset:1024
    ds_read_b128 v[132:135], v180 offset:4096
    v_mfma_f32_32x32x16_bf16 v[32:47], v[168:171], v[156:159], v[32:47]
    v_mfma_f32_32x32x16_bf16 v[48:63], v[172:175], v[156:159], v[48:63]
    s_waitcnt lgkmcnt(0)
    v_mfma_f32_32x32x16_bf16 v[0:15], v[144:147], v[128:131], v[0:15]
    ds_read_b64_tr_b16 v[168:169], v186 offset:4096
    ds_read_b64_tr_b16 v[170:171], v186 offset:5120
    ds_read_b128 v[152:155], v181 offset:0
    v_mfma_f32_32x32x16_bf16 v[16:31], v[148:151], v[128:131], v[16:31]
    ds_read_b64_tr_b16 v[172:173], v187 offset:4096
    ds_read_b64_tr_b16 v[174:175], v187 offset:5120
    ds_read_b128 v[156:159], v181 offset:4096
    v_mfma_f32_32x32x16_bf16 v[32:47], v[144:147], v[132:135], v[32:47]
    v_mfma_f32_32x32x16_bf16 v[48:63], v[148:151], v[132:135], v[48:63]
    s_waitcnt lgkmcnt(0)
    v_mfma_f32_32x32x16_bf16 v[0:15], v[168:171], v[152:155], v[0:15]
    ds_read_b64_tr_b16 v[144:145], v186 offset:8192
    ds_read_b64_tr_b16 v[146:147], v186 offset:9216
    ds_read_b128 v[128:131], v182 offset:0
    v_mfma_f32_32x32x16_bf16 v[16:31], v[172:175], v[152:155], v[16:31]
    ds_read_b64_tr_b16 v[148:149], v187 offset:8192
    ds_read_b64_tr_b16 v[150:151], v187 offset:9216
    ds_read_b128 v[132:135], v182 offset:4096
    v_mfma_f32_32x32x16_bf16 v[32:47], v[168:171], v[156:159], v[32:47]
    v_mfma_f32_32x32x16_bf16 v[48:63], v[172:175], v[156:159], v[48:63]
    s_waitcnt lgkmcnt(0)
    v_mfma_f32_32x32x16_bf16 v[0:15], v[144:147], v[128:131], v[0:15]
    ds_read_b64_tr_b16 v[168:169], v186 offset:12288
    ds_read_b64_tr_b16 v[170:171], v186 offset:13312
    ds_read_b128 v[152:155], v183 offset:0
    v_mfma_f32_32x32x16_bf16 v[16:31], v[148:151], v[128:131], v[16:31]
    ds_read_b64_tr_b16 v[172:173], v187 offset:12288
    ds_read_b64_tr_b16 v[174:175], v187 offset:13312
    ds_read_b128 v[156:159], v183 offset:4096
    v_mfma_f32_32x32x16_bf16 v[32:47], v[144:147], v[132:135], v[32:47]
    v_mfma_f32_32x32x16_bf16 v[48:63], v[148:151], v[132:135], v[48:63]
    s_waitcnt lgkmcnt(0)
    s_barrier
    v_mfma_f32_32x32x16_bf16 v[0:15], v[168:171], v[152:155], v[0:15]
    ds_read_b64_tr_b16 v[144:145], v184 offset:0
    ds_read_b64_tr_b16 v[146:147], v184 offset:1024
    ds_read_b128 v[128:131], v176 offset:0
    v_mfma_f32_32x32x16_bf16 v[16:31], v[172:175], v[152:155], v[16:31]
    ds_read_b64_tr_b16 v[148:149], v185 offset:0
    ds_read_b64_tr_b16 v[150:151], v185 offset:1024
    ds_read_b128 v[132:135], v176 offset:4096
    v_mfma_f32_32x32x16_bf16 v[32:47], v[168:171], v[156:159], v[32:47]
    v_mfma_f32_32x32x16_bf16 v[48:63], v[172:175], v[156:159], v[48:63]
    s_waitcnt lgkmcnt(0)
    v_mfma_f32_32x32x16_bf16 v[0:15], v[144:147], v[128:131], v[0:15]
    ds_read_b64_tr_b16 v[168:169], v184 offset:4096
    ds_read_b64_tr_b16 v[170:171], v184 offset:5120
    ds_read_b128 v[152:155], v177 offset:0
    v_mfma_f32_32x32x16_bf16 v[16:31], v[148:151], v[128:131], v[16:31]
    ds_read_b64_tr_b16 v[172:173], v185 offset:4096
    ds_read_b64_tr_b16 v[174:175], v185 offset:5120
    ds_read_b128 v[156:159], v177 offset:4096
    v_mfma_f32_32x32x16_bf16 v[32:47], v[144:147], v[132:135], v[32:47]
    v_mfma_f32_32x32x16_bf16 v[48:63], v[148:151], v[132:135], v[48:63]
    s_waitcnt lgkmcnt(0)
    v_mfma_f32_32x32x16_bf16 v[0:15], v[168:171], v[152:155], v[0:15]
    ds_read_b64_tr_b16 v[144:145], v184 offset:8192
    ds_read_b64_tr_b16 v[146:147], v184 offset:9216
    ds_read_b128 v[128:131], v178 offset:0
    v_mfma_f32_32x32x16_bf16 v[16:31], v[172:175], v[152:155], v[16:31]
    ds_read_b64_tr_b16 v[148:149], v185 offset:8192
    ds_read_b64_tr_b16 v[150:151], v185 offset:9216
    ds_read_b128 v[132:135], v178 offset:4096
    v_mfma_f32_32x32x16_bf16 v[32:47], v[168:171], v[156:159], v[32:47]
    v_mfma_f32_32x32x16_bf16 v[48:63], v[172:175], v[156:159], v[48:63]
    s_waitcnt lgkmcnt(0)
    v_mfma_f32_32x32x16_bf16 v[0:15], v[144:147], v[128:131], v[0:15]
    ds_read_b64_tr_b16 v[168:169], v184 offset:12288
    ds_read_b64_tr_b16 v[170:171], v184 offset:13312
    ds_read_b128 v[152:155], v179 offset:0
    v_mfma_f32_32x32x16_bf16 v[16:31], v[148:151], v[128:131], v[16:31]
    ds_read_b64_tr_b16 v[172:173], v185 offset:12288
    ds_read_b64_tr_b16 v[174:175], v185 offset:13312
    ds_read_b128 v[156:159], v179 offset:4096
    v_mfma_f32_32x32x16_bf16 v[32:47], v[144:147], v[132:135], v[32:47]
    v_mfma_f32_32x32x16_bf16 v[48:63], v[148:151], v[132:135], v[48:63]
    s_waitcnt lgkmcnt(0)
    s_barrier
    v_mfma_f32_32x32x16_bf16 v[0:15], v[168:171], v[152:155], v[0:15]
    ds_read_b64_tr_b16 v[144:145], v184 offset:32768
    ds_read_b64_tr_b16 v[146:147], v184 offset:33792
    ds_read_b128 v[128:131], v176 offset:32768
    v_mfma_f32_32x32x16_bf16 v[16:31], v[172:175], v[152:155], v[16:31]
    ds_read_b64_tr_b16 v[148:149], v185 offset:32768
    ds_read_b64_tr_b16 v[150:151], v185 offset:33792
    ds_read_b128 v[132:135], v176 offset:36864
    v_mfma_f32_32x32x16_bf16 v[32:47], v[168:171], v[156:159], v[32:47]
    v_mfma_f32_32x32x16_bf16 v[48:63], v[172:175], v[156:159], v[48:63]
    s_waitcnt lgkmcnt(0)
    v_mfma_f32_32x32x16_bf16 v[0:15], v[144:147], v[128:131], v[0:15]
    ds_read_b64_tr_b16 v[168:169], v184 offset:36864
    ds_read_b64_tr_b16 v[170:171], v184 offset:37888
    ds_read_b128 v[152:155], v177 offset:32768
    v_mfma_f32_32x32x16_bf16 v[16:31], v[148:151], v[128:131], v[16:31]
    ds_read_b64_tr_b16 v[172:173], v185 offset:36864
    ds_read_b64_tr_b16 v[174:175], v185 offset:37888
    ds_read_b128 v[156:159], v177 offset:36864
    v_mfma_f32_32x32x16_bf16 v[32:47], v[144:147], v[132:135], v[32:47]
    v_mfma_f32_32x32x16_bf16 v[48:63], v[148:151], v[132:135], v[48:63]
    s_waitcnt lgkmcnt(0)
    v_mfma_f32_32x32x16_bf16 v[0:15], v[168:171], v[152:155], v[0:15]
    ds_read_b64_tr_b16 v[144:145], v184 offset:40960
    ds_read_b64_tr_b16 v[146:147], v184 offset:41984
    ds_read_b128 v[128:131], v178 offset:32768
    v_mfma_f32_32x32x16_bf16 v[16:31], v[172:175], v[152:155], v[16:31]
    ds_read_b64_tr_b16 v[148:149], v185 offset:40960
    ds_read_b64_tr_b16 v[150:151], v185 offset:41984
    ds_read_b128 v[132:135], v178 offset:36864
    v_mfma_f32_32x32x16_bf16 v[32:47], v[168:171], v[156:159], v[32:47]
    v_mfma_f32_32x32x16_bf16 v[48:63], v[172:175], v[156:159], v[48:63]
    s_waitcnt lgkmcnt(0)
    v_mfma_f32_32x32x16_bf16 v[0:15], v[144:147], v[128:131], v[0:15]
    ds_read_b64_tr_b16 v[168:169], v184 offset:45056
    ds_read_b64_tr_b16 v[170:171], v184 offset:46080
    ds_read_b128 v[152:155], v179 offset:32768
    v_mfma_f32_32x32x16_bf16 v[16:31], v[148:151], v[128:131], v[16:31]
    ds_read_b64_tr_b16 v[172:173], v185 offset:45056
    ds_read_b64_tr_b16 v[174:175], v185 offset:46080
    ds_read_b128 v[156:159], v179 offset:36864
    v_mfma_f32_32x32x16_bf16 v[32:47], v[144:147], v[132:135], v[32:47]
    v_mfma_f32_32x32x16_bf16 v[48:63], v[148:151], v[132:135], v[48:63]
    s_waitcnt lgkmcnt(0)
    s_barrier
    v_mfma_f32_32x32x16_bf16 v[0:15], v[168:171], v[152:155], v[0:15]
    ds_read_b64_tr_b16 v[144:145], v186 offset:0
    ds_read_b64_tr_b16 v[146:147], v186 offset:1024
    ds_read_b128 v[128:131], v180 offset:0
    v_mfma_f32_32x32x16_bf16 v[16:31], v[172:175], v[152:155], v[16:31]
    ds_read_b64_tr_b16 v[148:149], v187 offset:0
    ds_read_b64_tr_b16 v[150:151], v187 offset:1024
    ds_read_b128 v[132:135], v180 offset:4096
    v_mfma_f32_32x32x16_bf16 v[32:47], v[168:171], v[156:159], v[32:47]
    v_mfma_f32_32x32x16_bf16 v[48:63], v[172:175], v[156:159], v[48:63]
    s_waitcnt lgkmcnt(0)
    v_mfma_f32_32x32x16_bf16 v[0:15], v[144:147], v[128:131], v[0:15]
    ds_read_b64_tr_b16 v[168:169], v186 offset:4096
    ds_read_b64_tr_b16 v[170:171], v186 offset:5120
    ds_read_b128 v[152:155], v181 offset:0
    v_mfma_f32_32x32x16_bf16 v[16:31], v[148:151], v[128:131], v[16:31]
    ds_read_b64_tr_b16 v[172:173], v187 offset:4096
    ds_read_b64_tr_b16 v[174:175], v187 offset:5120
    ds_read_b128 v[156:159], v181 offset:4096
    v_mfma_f32_32x32x16_bf16 v[32:47], v[144:147], v[132:135], v[32:47]
    v_mfma_f32_32x32x16_bf16 v[48:63], v[148:151], v[132:135], v[48:63]
    s_waitcnt lgkmcnt(0)
    v_mfma_f32_32x32x16_bf16 v[0:15], v[168:171], v[152:155], v[0:15]
    ds_read_b64_tr_b16 v[144:145], v186 offset:8192
    ds_read_b64_tr_b16 v[146:147], v186 offset:9216
    ds_read_b128 v[128:131], v182 offset:0
    v_mfma_f32_32x32x16_bf16 v[16:31], v[172:175], v[152:155], v[16:31]
    ds_read_b64_tr_b16 v[148:149], v187 offset:8192
    ds_read_b64_tr_b16 v[150:151], v187 offset:9216
    ds_read_b128 v[132:135], v182 offset:4096
    v_mfma_f32_32x32x16_bf16 v[32:47], v[168:171], v[156:159], v[32:47]
    v_mfma_f32_32x32x16_bf16 v[48:63], v[172:175], v[156:159], v[48:63]
    s_waitcnt lgkmcnt(0)
    v_mfma_f32_32x32x16_bf16 v[0:15], v[144:147], v[128:131], v[0:15]
    ds_read_b64_tr_b16 v[168:169], v186 offset:12288
    ds_read_b64_tr_b16 v[170:171], v186 offset:13312
    ds_read_b128 v[152:155], v183 offset:0
    v_mfma_f32_32x32x16_bf16 v[16:31], v[148:151], v[128:131], v[16:31]
    ds_read_b64_tr_b16 v[172:173], v187 offset:12288
    ds_read_b64_tr_b16 v[174:175], v187 offset:13312
    ds_read_b128 v[156:159], v183 offset:4096
    v_mfma_f32_32x32x16_bf16 v[32:47], v[144:147], v[132:135], v[32:47]
    v_mfma_f32_32x32x16_bf16 v[48:63], v[148:151], v[132:135], v[48:63]
    s_waitcnt lgkmcnt(0)
    s_barrier
    v_mfma_f32_32x32x16_bf16 v[0:15], v[168:171], v[152:155], v[0:15]
    ds_read_b64_tr_b16 v[144:145], v184 offset:0
    ds_read_b64_tr_b16 v[146:147], v184 offset:1024
    ds_read_b128 v[128:131], v176 offset:0
    v_mfma_f32_32x32x16_bf16 v[16:31], v[172:175], v[152:155], v[16:31]
    ds_read_b64_tr_b16 v[148:149], v185 offset:0
    ds_read_b64_tr_b16 v[150:151], v185 offset:1024
    ds_read_b128 v[132:135], v176 offset:4096
    v_mfma_f32_32x32x16_bf16 v[32:47], v[168:171], v[156:159], v[32:47]
    v_mfma_f32_32x32x16_bf16 v[48:63], v[172:175], v[156:159], v[48:63]
    s_waitcnt lgkmcnt(0)
    v_mfma_f32_32x32x16_bf16 v[0:15], v[144:147], v[128:131], v[0:15]
    ds_read_b64_tr_b16 v[168:169], v184 offset:4096
    ds_read_b64_tr_b16 v[170:171], v184 offset:5120
    ds_read_b128 v[152:155], v177 offset:0
    v_mfma_f32_32x32x16_bf16 v[16:31], v[148:151], v[128:131], v[16:31]
    ds_read_b64_tr_b16 v[172:173], v185 offset:4096
    ds_read_b64_tr_b16 v[174:175], v185 offset:5120
    ds_read_b128 v[156:159], v177 offset:4096
    v_mfma_f32_32x32x16_bf16 v[32:47], v[144:147], v[132:135], v[32:47]
    v_mfma_f32_32x32x16_bf16 v[48:63], v[148:151], v[132:135], v[48:63]
    s_waitcnt lgkmcnt(0)
    v_mfma_f32_32x32x16_bf16 v[0:15], v[168:171], v[152:155], v[0:15]
    ds_read_b64_tr_b16 v[144:145], v184 offset:8192
    ds_read_b64_tr_b16 v[146:147], v184 offset:9216
    ds_read_b128 v[128:131], v178 offset:0
    v_mfma_f32_32x32x16_bf16 v[16:31], v[172:175], v[152:155], v[16:31]
    ds_read_b64_tr_b16 v[148:149], v185 offset:8192
    ds_read_b64_tr_b16 v[150:151], v185 offset:9216
    ds_read_b128 v[132:135], v178 offset:4096
    v_mfma_f32_32x32x16_bf16 v[32:47], v[168:171], v[156:159], v[32:47]
    v_mfma_f32_32x32x16_bf16 v[48:63], v[172:175], v[156:159], v[48:63]
    s_waitcnt lgkmcnt(0)
    v_mfma_f32_32x32x16_bf16 v[0:15], v[144:147], v[128:131], v[0:15]
    ds_read_b64_tr_b16 v[168:169], v184 offset:12288
    ds_read_b64_tr_b16 v[170:171], v184 offset:13312
    ds_read_b128 v[152:155], v179 offset:0
    v_mfma_f32_32x32x16_bf16 v[16:31], v[148:151], v[128:131], v[16:31]
    ds_read_b64_tr_b16 v[172:173], v185 offset:12288
    ds_read_b64_tr_b16 v[174:175], v185 offset:13312
    ds_read_b128 v[156:159], v179 offset:4096
    v_mfma_f32_32x32x16_bf16 v[32:47], v[144:147], v[132:135], v[32:47]
    v_mfma_f32_32x32x16_bf16 v[48:63], v[148:151], v[132:135], v[48:63]
    s_waitcnt lgkmcnt(0)
    v_mfma_f32_32x32x16_bf16 v[0:15], v[168:171], v[152:155], v[0:15]
    v_mfma_f32_32x32x16_bf16 v[16:31], v[172:175], v[152:155], v[16:31]
    v_mfma_f32_32x32x16_bf16 v[32:47], v[168:171], v[156:159], v[32:47]
    v_mfma_f32_32x32x16_bf16 v[48:63], v[172:175], v[156:159], v[48:63]
    s_nop 15
    s_cmp_lt_u32 s9, 5
    s_cselect_b32 s41, 0, 2621440
    s_cselect_b32 s42, 0, 5
    s_sub_u32 s42, s9, s42
    s_mul_i32 s43, s5, 5242880
    s_add_u32 s41, s41, s43
    s_add_u32 s44, s20, s41
    s_addc_u32 s45, s21, 0

    s_mov_b32 s48, s44
    s_and_b32 s49, s45, 0xffff
    s_mov_b32 s50, 2621440
    s_mov_b32 s51, 0x20000
    s_lshl_b32 s46, s8, 2
    s_lshl_b32 s47, s12, 1
    s_add_u32 s46, s46, s47
    s_mul_i32 s46, s46, 40960
    s_lshl_b32 s47, s42, 4
    s_lshl_b32 s52, s13, 3
    s_add_u32 s47, s47, s52
    s_lshl_b32 s47, s47, 9
    s_add_u32 s46, s46, s47
    v_lshlrev_b32 v189, 4, v188

    s_mov_b32 s56, 1051011932
    s_mov_b32 s57, 1051011932
    s_cmp_lt_u32 s9, 5
    s_cbranch_scc0 K1_KTILE
    v_pk_mul_f32 v[0:1], v[0:1], s[56:57]
    v_pk_mul_f32 v[2:3], v[2:3], s[56:57]
    v_pk_mul_f32 v[4:5], v[4:5], s[56:57]
    v_pk_mul_f32 v[6:7], v[6:7], s[56:57]
    v_pk_mul_f32 v[8:9], v[8:9], s[56:57]
    v_pk_mul_f32 v[10:11], v[10:11], s[56:57]
    v_pk_mul_f32 v[12:13], v[12:13], s[56:57]
    v_pk_mul_f32 v[14:15], v[14:15], s[56:57]
    v_cvt_pk_bf16_f32 v128, v0, v1
    v_cvt_pk_bf16_f32 v129, v2, v3
    v_cvt_pk_bf16_f32 v130, v4, v5
    v_cvt_pk_bf16_f32 v131, v6, v7
    s_add_u32 s53, s46, 0
    s_nop 0
    v_permlane32_swap_b32 v128, v130
    v_permlane32_swap_b32 v129, v131
    buffer_store_dwordx4 v[128:131], v189, s[48:51], s53 offen sc1
    v_cvt_pk_bf16_f32 v132, v8, v9
    v_cvt_pk_bf16_f32 v133, v10, v11
    v_cvt_pk_bf16_f32 v134, v12, v13
    v_cvt_pk_bf16_f32 v135, v14, v15
    s_add_u32 s53, s46, 1024
    s_nop 0
    v_permlane32_swap_b32 v132, v134
    v_permlane32_swap_b32 v133, v135
    buffer_store_dwordx4 v[132:135], v189, s[48:51], s53 offen sc1
    v_pk_mul_f32 v[16:17], v[16:17], s[56:57]
    v_pk_mul_f32 v[18:19], v[18:19], s[56:57]
    v_pk_mul_f32 v[20:21], v[20:21], s[56:57]
    v_pk_mul_f32 v[22:23], v[22:23], s[56:57]
    v_pk_mul_f32 v[24:25], v[24:25], s[56:57]
    v_pk_mul_f32 v[26:27], v[26:27], s[56:57]
    v_pk_mul_f32 v[28:29], v[28:29], s[56:57]
    v_pk_mul_f32 v[30:31], v[30:31], s[56:57]
    v_cvt_pk_bf16_f32 v136, v16, v17
    v_cvt_pk_bf16_f32 v137, v18, v19
    v_cvt_pk_bf16_f32 v138, v20, v21
    v_cvt_pk_bf16_f32 v139, v22, v23
    s_add_u32 s53, s46, 2048
    s_nop 0
    v_permlane32_swap_b32 v136, v138
    v_permlane32_swap_b32 v137, v139
    buffer_store_dwordx4 v[136:139], v189, s[48:51], s53 offen sc1
    v_cvt_pk_bf16_f32 v140, v24, v25
    v_cvt_pk_bf16_f32 v141, v26, v27
    v_cvt_pk_bf16_f32 v142, v28, v29
    v_cvt_pk_bf16_f32 v143, v30, v31
    s_add_u32 s53, s46, 3072
    s_nop 0
    v_permlane32_swap_b32 v140, v142
    v_permlane32_swap_b32 v141, v143
    buffer_store_dwordx4 v[140:143], v189, s[48:51], s53 offen sc1
    v_pk_mul_f32 v[32:33], v[32:33], s[56:57]
    v_pk_mul_f32 v[34:35], v[34:35], s[56:57]
    v_pk_mul_f32 v[36:37], v[36:37], s[56:57]
    v_pk_mul_f32 v[38:39], v[38:39], s[56:57]
    v_pk_mul_f32 v[40:41], v[40:41], s[56:57]
    v_pk_mul_f32 v[42:43], v[42:43], s[56:57]
    v_pk_mul_f32 v[44:45], v[44:45], s[56:57]
    v_pk_mul_f32 v[46:47], v[46:47], s[56:57]
    v_cvt_pk_bf16_f32 v128, v32, v33
    v_cvt_pk_bf16_f32 v129, v34, v35
    v_cvt_pk_bf16_f32 v130, v36, v37
    v_cvt_pk_bf16_f32 v131, v38, v39
    s_add_u32 s53, s46, 40960
    s_nop 0
    v_permlane32_swap_b32 v128, v130
    v_permlane32_swap_b32 v129, v131
    buffer_store_dwordx4 v[128:131], v189, s[48:51], s53 offen sc1
    v_cvt_pk_bf16_f32 v132, v40, v41
    v_cvt_pk_bf16_f32 v133, v42, v43
    v_cvt_pk_bf16_f32 v134, v44, v45
    v_cvt_pk_bf16_f32 v135, v46, v47
    s_add_u32 s53, s46, 41984
    s_nop 0
    v_permlane32_swap_b32 v132, v134
    v_permlane32_swap_b32 v133, v135
    buffer_store_dwordx4 v[132:135], v189, s[48:51], s53 offen sc1
    v_pk_mul_f32 v[48:49], v[48:49], s[56:57]
    v_pk_mul_f32 v[50:51], v[50:51], s[56:57]
    v_pk_mul_f32 v[52:53], v[52:53], s[56:57]
    v_pk_mul_f32 v[54:55], v[54:55], s[56:57]
    v_pk_mul_f32 v[56:57], v[56:57], s[56:57]
    v_pk_mul_f32 v[58:59], v[58:59], s[56:57]
    v_pk_mul_f32 v[60:61], v[60:61], s[56:57]
    v_pk_mul_f32 v[62:63], v[62:63], s[56:57]
    v_cvt_pk_bf16_f32 v136, v48, v49
    v_cvt_pk_bf16_f32 v137, v50, v51
    v_cvt_pk_bf16_f32 v138, v52, v53
    v_cvt_pk_bf16_f32 v139, v54, v55
    s_add_u32 s53, s46, 43008
    s_nop 0
    v_permlane32_swap_b32 v136, v138
    v_permlane32_swap_b32 v137, v139
    buffer_store_dwordx4 v[136:139], v189, s[48:51], s53 offen sc1
    v_cvt_pk_bf16_f32 v140, v56, v57
    v_cvt_pk_bf16_f32 v141, v58, v59
    v_cvt_pk_bf16_f32 v142, v60, v61
    v_cvt_pk_bf16_f32 v143, v62, v63
    s_add_u32 s53, s46, 44032
    s_nop 0
    v_permlane32_swap_b32 v140, v142
    v_permlane32_swap_b32 v141, v143
    buffer_store_dwordx4 v[140:143], v189, s[48:51], s53 offen sc1
    s_endpgm
K1_KTILE:
    v_cvt_pk_bf16_f32 v128, v0, v1
    v_cvt_pk_bf16_f32 v129, v2, v3
    v_cvt_pk_bf16_f32 v130, v4, v5
    v_cvt_pk_bf16_f32 v131, v6, v7
    s_add_u32 s53, s46, 0
    s_nop 0
    v_permlane32_swap_b32 v128, v130
    v_permlane32_swap_b32 v129, v131
    buffer_store_dwordx4 v[128:131], v189, s[48:51], s53 offen sc1
    v_cvt_pk_bf16_f32 v132, v8, v9
    v_cvt_pk_bf16_f32 v133, v10, v11
    v_cvt_pk_bf16_f32 v134, v12, v13
    v_cvt_pk_bf16_f32 v135, v14, v15
    s_add_u32 s53, s46, 1024
    s_nop 0
    v_permlane32_swap_b32 v132, v134
    v_permlane32_swap_b32 v133, v135
    buffer_store_dwordx4 v[132:135], v189, s[48:51], s53 offen sc1
    v_cvt_pk_bf16_f32 v136, v16, v17
    v_cvt_pk_bf16_f32 v137, v18, v19
    v_cvt_pk_bf16_f32 v138, v20, v21
    v_cvt_pk_bf16_f32 v139, v22, v23
    s_add_u32 s53, s46, 2048
    s_nop 0
    v_permlane32_swap_b32 v136, v138
    v_permlane32_swap_b32 v137, v139
    buffer_store_dwordx4 v[136:139], v189, s[48:51], s53 offen sc1
    v_cvt_pk_bf16_f32 v140, v24, v25
    v_cvt_pk_bf16_f32 v141, v26, v27
    v_cvt_pk_bf16_f32 v142, v28, v29
    v_cvt_pk_bf16_f32 v143, v30, v31
    s_add_u32 s53, s46, 3072
    s_nop 0
    v_permlane32_swap_b32 v140, v142
    v_permlane32_swap_b32 v141, v143
    buffer_store_dwordx4 v[140:143], v189, s[48:51], s53 offen sc1
    v_cvt_pk_bf16_f32 v128, v32, v33
    v_cvt_pk_bf16_f32 v129, v34, v35
    v_cvt_pk_bf16_f32 v130, v36, v37
    v_cvt_pk_bf16_f32 v131, v38, v39
    s_add_u32 s53, s46, 40960
    s_nop 0
    v_permlane32_swap_b32 v128, v130
    v_permlane32_swap_b32 v129, v131
    buffer_store_dwordx4 v[128:131], v189, s[48:51], s53 offen sc1
    v_cvt_pk_bf16_f32 v132, v40, v41
    v_cvt_pk_bf16_f32 v133, v42, v43
    v_cvt_pk_bf16_f32 v134, v44, v45
    v_cvt_pk_bf16_f32 v135, v46, v47
    s_add_u32 s53, s46, 41984
    s_nop 0
    v_permlane32_swap_b32 v132, v134
    v_permlane32_swap_b32 v133, v135
    buffer_store_dwordx4 v[132:135], v189, s[48:51], s53 offen sc1
    v_cvt_pk_bf16_f32 v136, v48, v49
    v_cvt_pk_bf16_f32 v137, v50, v51
    v_cvt_pk_bf16_f32 v138, v52, v53
    v_cvt_pk_bf16_f32 v139, v54, v55
    s_add_u32 s53, s46, 43008
    s_nop 0
    v_permlane32_swap_b32 v136, v138
    v_permlane32_swap_b32 v137, v139
    buffer_store_dwordx4 v[136:139], v189, s[48:51], s53 offen sc1
    v_cvt_pk_bf16_f32 v140, v56, v57
    v_cvt_pk_bf16_f32 v141, v58, v59
    v_cvt_pk_bf16_f32 v142, v60, v61
    v_cvt_pk_bf16_f32 v143, v62, v63
    s_add_u32 s53, s46, 44032
    s_nop 0
    v_permlane32_swap_b32 v140, v142
    v_permlane32_swap_b32 v141, v143
    buffer_store_dwordx4 v[140:143], v189, s[48:51], s53 offen sc1
    s_endpgm
K1_VTILE:
    s_barrier
    ds_read_b64_tr_b16 v[144:145], v184 offset:0
    ds_read_b64_tr_b16 v[146:147], v184 offset:1024
    ds_read_b64_tr_b16 v[148:149], v185 offset:0
    ds_read_b64_tr_b16 v[150:151], v185 offset:1024
    ds_read_b128 v[128:131], v176 offset:0
    ds_read_b128 v[132:135], v176 offset:4096
    s_waitcnt lgkmcnt(0)
    v_mfma_f32_32x32x16_bf16 v[0:15], v[128:131], v[144:147], v[0:15]
    ds_read_b64_tr_b16 v[168:169], v184 offset:4096
    ds_read_b64_tr_b16 v[170:171], v184 offset:5120
    ds_read_b128 v[152:155], v177 offset:0
    v_mfma_f32_32x32x16_bf16 v[16:31], v[128:131], v[148:151], v[16:31]
    ds_read_b64_tr_b16 v[172:173], v185 offset:4096
    ds_read_b64_tr_b16 v[174:175], v185 offset:5120
    ds_read_b128 v[156:159], v177 offset:4096
    v_mfma_f32_32x32x16_bf16 v[32:47], v[132:135], v[144:147], v[32:47]
    v_mfma_f32_32x32x16_bf16 v[48:63], v[132:135], v[148:151], v[48:63]
    s_waitcnt lgkmcnt(0)
    v_mfma_f32_32x32x16_bf16 v[0:15], v[152:155], v[168:171], v[0:15]
    ds_read_b64_tr_b16 v[144:145], v184 offset:8192
    ds_read_b64_tr_b16 v[146:147], v184 offset:9216
    ds_read_b128 v[128:131], v178 offset:0
    v_mfma_f32_32x32x16_bf16 v[16:31], v[152:155], v[172:175], v[16:31]
    ds_read_b64_tr_b16 v[148:149], v185 offset:8192
    ds_read_b64_tr_b16 v[150:151], v185 offset:9216
    ds_read_b128 v[132:135], v178 offset:4096
    v_mfma_f32_32x32x16_bf16 v[32:47], v[156:159], v[168:171], v[32:47]
    v_mfma_f32_32x32x16_bf16 v[48:63], v[156:159], v[172:175], v[48:63]
    s_waitcnt lgkmcnt(0)
    v_mfma_f32_32x32x16_bf16 v[0:15], v[128:131], v[144:147], v[0:15]
    ds_read_b64_tr_b16 v[168:169], v184 offset:12288
    ds_read_b64_tr_b16 v[170:171], v184 offset:13312
    ds_read_b128 v[152:155], v179 offset:0
    v_mfma_f32_32x32x16_bf16 v[16:31], v[128:131], v[148:151], v[16:31]
    ds_read_b64_tr_b16 v[172:173], v185 offset:12288
    ds_read_b64_tr_b16 v[174:175], v185 offset:13312
    ds_read_b128 v[156:159], v179 offset:4096
    v_mfma_f32_32x32x16_bf16 v[32:47], v[132:135], v[144:147], v[32:47]
    v_mfma_f32_32x32x16_bf16 v[48:63], v[132:135], v[148:151], v[48:63]
    s_waitcnt lgkmcnt(0)
    s_barrier
    v_mfma_f32_32x32x16_bf16 v[0:15], v[152:155], v[168:171], v[0:15]
    ds_read_b64_tr_b16 v[144:145], v184 offset:32768
    ds_read_b64_tr_b16 v[146:147], v184 offset:33792
    ds_read_b128 v[128:131], v176 offset:32768
    v_mfma_f32_32x32x16_bf16 v[16:31], v[152:155], v[172:175], v[16:31]
    ds_read_b64_tr_b16 v[148:149], v185 offset:32768
    ds_read_b64_tr_b16 v[150:151], v185 offset:33792
    ds_read_b128 v[132:135], v176 offset:36864
    v_mfma_f32_32x32x16_bf16 v[32:47], v[156:159], v[168:171], v[32:47]
    v_mfma_f32_32x32x16_bf16 v[48:63], v[156:159], v[172:175], v[48:63]
    s_waitcnt lgkmcnt(0)
    v_mfma_f32_32x32x16_bf16 v[0:15], v[128:131], v[144:147], v[0:15]
    ds_read_b64_tr_b16 v[168:169], v184 offset:36864
    ds_read_b64_tr_b16 v[170:171], v184 offset:37888
    ds_read_b128 v[152:155], v177 offset:32768
    v_mfma_f32_32x32x16_bf16 v[16:31], v[128:131], v[148:151], v[16:31]
    ds_read_b64_tr_b16 v[172:173], v185 offset:36864
    ds_read_b64_tr_b16 v[174:175], v185 offset:37888
    ds_read_b128 v[156:159], v177 offset:36864
    v_mfma_f32_32x32x16_bf16 v[32:47], v[132:135], v[144:147], v[32:47]
    v_mfma_f32_32x32x16_bf16 v[48:63], v[132:135], v[148:151], v[48:63]
    s_waitcnt lgkmcnt(0)
    v_mfma_f32_32x32x16_bf16 v[0:15], v[152:155], v[168:171], v[0:15]
    ds_read_b64_tr_b16 v[144:145], v184 offset:40960
    ds_read_b64_tr_b16 v[146:147], v184 offset:41984
    ds_read_b128 v[128:131], v178 offset:32768
    v_mfma_f32_32x32x16_bf16 v[16:31], v[152:155], v[172:175], v[16:31]
    ds_read_b64_tr_b16 v[148:149], v185 offset:40960
    ds_read_b64_tr_b16 v[150:151], v185 offset:41984
    ds_read_b128 v[132:135], v178 offset:36864
    v_mfma_f32_32x32x16_bf16 v[32:47], v[156:159], v[168:171], v[32:47]
    v_mfma_f32_32x32x16_bf16 v[48:63], v[156:159], v[172:175], v[48:63]
    s_waitcnt lgkmcnt(0)
    v_mfma_f32_32x32x16_bf16 v[0:15], v[128:131], v[144:147], v[0:15]
    ds_read_b64_tr_b16 v[168:169], v184 offset:45056
    ds_read_b64_tr_b16 v[170:171], v184 offset:46080
    ds_read_b128 v[152:155], v179 offset:32768
    v_mfma_f32_32x32x16_bf16 v[16:31], v[128:131], v[148:151], v[16:31]
    ds_read_b64_tr_b16 v[172:173], v185 offset:45056
    ds_read_b64_tr_b16 v[174:175], v185 offset:46080
    ds_read_b128 v[156:159], v179 offset:36864
    v_mfma_f32_32x32x16_bf16 v[32:47], v[132:135], v[144:147], v[32:47]
    v_mfma_f32_32x32x16_bf16 v[48:63], v[132:135], v[148:151], v[48:63]
    s_waitcnt lgkmcnt(0)
    s_barrier
    v_mfma_f32_32x32x16_bf16 v[0:15], v[152:155], v[168:171], v[0:15]
    ds_read_b64_tr_b16 v[144:145], v186 offset:0
    ds_read_b64_tr_b16 v[146:147], v186 offset:1024
    ds_read_b128 v[128:131], v180 offset:0
    v_mfma_f32_32x32x16_bf16 v[16:31], v[152:155], v[172:175], v[16:31]
    ds_read_b64_tr_b16 v[148:149], v187 offset:0
    ds_read_b64_tr_b16 v[150:151], v187 offset:1024
    ds_read_b128 v[132:135], v180 offset:4096
    v_mfma_f32_32x32x16_bf16 v[32:47], v[156:159], v[168:171], v[32:47]
    v_mfma_f32_32x32x16_bf16 v[48:63], v[156:159], v[172:175], v[48:63]
    s_waitcnt lgkmcnt(0)
    v_mfma_f32_32x32x16_bf16 v[0:15], v[128:131], v[144:147], v[0:15]
    ds_read_b64_tr_b16 v[168:169], v186 offset:4096
    ds_read_b64_tr_b16 v[170:171], v186 offset:5120
    ds_read_b128 v[152:155], v181 offset:0
    v_mfma_f32_32x32x16_bf16 v[16:31], v[128:131], v[148:151], v[16:31]
    ds_read_b64_tr_b16 v[172:173], v187 offset:4096
    ds_read_b64_tr_b16 v[174:175], v187 offset:5120
    ds_read_b128 v[156:159], v181 offset:4096
    v_mfma_f32_32x32x16_bf16 v[32:47], v[132:135], v[144:147], v[32:47]
    v_mfma_f32_32x32x16_bf16 v[48:63], v[132:135], v[148:151], v[48:63]
    s_waitcnt lgkmcnt(0)
    v_mfma_f32_32x32x16_bf16 v[0:15], v[152:155], v[168:171], v[0:15]
    ds_read_b64_tr_b16 v[144:145], v186 offset:8192
    ds_read_b64_tr_b16 v[146:147], v186 offset:9216
    ds_read_b128 v[128:131], v182 offset:0
    v_mfma_f32_32x32x16_bf16 v[16:31], v[152:155], v[172:175], v[16:31]
    ds_read_b64_tr_b16 v[148:149], v187 offset:8192
    ds_read_b64_tr_b16 v[150:151], v187 offset:9216
    ds_read_b128 v[132:135], v182 offset:4096
    v_mfma_f32_32x32x16_bf16 v[32:47], v[156:159], v[168:171], v[32:47]
    v_mfma_f32_32x32x16_bf16 v[48:63], v[156:159], v[172:175], v[48:63]
    s_waitcnt lgkmcnt(0)
    v_mfma_f32_32x32x16_bf16 v[0:15], v[128:131], v[144:147], v[0:15]
    ds_read_b64_tr_b16 v[168:169], v186 offset:12288
    ds_read_b64_tr_b16 v[170:171], v186 offset:13312
    ds_read_b128 v[152:155], v183 offset:0
    v_mfma_f32_32x32x16_bf16 v[16:31], v[128:131], v[148:151], v[16:31]
    ds_read_b64_tr_b16 v[172:173], v187 offset:12288
    ds_read_b64_tr_b16 v[174:175], v187 offset:13312
    ds_read_b128 v[156:159], v183 offset:4096
    v_mfma_f32_32x32x16_bf16 v[32:47], v[132:135], v[144:147], v[32:47]
    v_mfma_f32_32x32x16_bf16 v[48:63], v[132:135], v[148:151], v[48:63]
    s_waitcnt lgkmcnt(0)
    s_barrier
    v_mfma_f32_32x32x16_bf16 v[0:15], v[152:155], v[168:171], v[0:15]
    ds_read_b64_tr_b16 v[144:145], v184 offset:0
    ds_read_b64_tr_b16 v[146:147], v184 offset:1024
    ds_read_b128 v[128:131], v176 offset:0
    v_mfma_f32_32x32x16_bf16 v[16:31], v[152:155], v[172:175], v[16:31]
    ds_read_b64_tr_b16 v[148:149], v185 offset:0
    ds_read_b64_tr_b16 v[150:151], v185 offset:1024
    ds_read_b128 v[132:135], v176 offset:4096
    v_mfma_f32_32x32x16_bf16 v[32:47], v[156:159], v[168:171], v[32:47]
    v_mfma_f32_32x32x16_bf16 v[48:63], v[156:159], v[172:175], v[48:63]
    s_waitcnt lgkmcnt(0)
    v_mfma_f32_32x32x16_bf16 v[0:15], v[128:131], v[144:147], v[0:15]
    ds_read_b64_tr_b16 v[168:169], v184 offset:4096
    ds_read_b64_tr_b16 v[170:171], v184 offset:5120
    ds_read_b128 v[152:155], v177 offset:0
    v_mfma_f32_32x32x16_bf16 v[16:31], v[128:131], v[148:151], v[16:31]
    ds_read_b64_tr_b16 v[172:173], v185 offset:4096
    ds_read_b64_tr_b16 v[174:175], v185 offset:5120
    ds_read_b128 v[156:159], v177 offset:4096
    v_mfma_f32_32x32x16_bf16 v[32:47], v[132:135], v[144:147], v[32:47]
    v_mfma_f32_32x32x16_bf16 v[48:63], v[132:135], v[148:151], v[48:63]
    s_waitcnt lgkmcnt(0)
    v_mfma_f32_32x32x16_bf16 v[0:15], v[152:155], v[168:171], v[0:15]
    ds_read_b64_tr_b16 v[144:145], v184 offset:8192
    ds_read_b64_tr_b16 v[146:147], v184 offset:9216
    ds_read_b128 v[128:131], v178 offset:0
    v_mfma_f32_32x32x16_bf16 v[16:31], v[152:155], v[172:175], v[16:31]
    ds_read_b64_tr_b16 v[148:149], v185 offset:8192
    ds_read_b64_tr_b16 v[150:151], v185 offset:9216
    ds_read_b128 v[132:135], v178 offset:4096
    v_mfma_f32_32x32x16_bf16 v[32:47], v[156:159], v[168:171], v[32:47]
    v_mfma_f32_32x32x16_bf16 v[48:63], v[156:159], v[172:175], v[48:63]
    s_waitcnt lgkmcnt(0)
    v_mfma_f32_32x32x16_bf16 v[0:15], v[128:131], v[144:147], v[0:15]
    ds_read_b64_tr_b16 v[168:169], v184 offset:12288
    ds_read_b64_tr_b16 v[170:171], v184 offset:13312
    ds_read_b128 v[152:155], v179 offset:0
    v_mfma_f32_32x32x16_bf16 v[16:31], v[128:131], v[148:151], v[16:31]
    ds_read_b64_tr_b16 v[172:173], v185 offset:12288
    ds_read_b64_tr_b16 v[174:175], v185 offset:13312
    ds_read_b128 v[156:159], v179 offset:4096
    v_mfma_f32_32x32x16_bf16 v[32:47], v[132:135], v[144:147], v[32:47]
    v_mfma_f32_32x32x16_bf16 v[48:63], v[132:135], v[148:151], v[48:63]
    s_waitcnt lgkmcnt(0)
    s_barrier
    v_mfma_f32_32x32x16_bf16 v[0:15], v[152:155], v[168:171], v[0:15]
    ds_read_b64_tr_b16 v[144:145], v184 offset:32768
    ds_read_b64_tr_b16 v[146:147], v184 offset:33792
    ds_read_b128 v[128:131], v176 offset:32768
    v_mfma_f32_32x32x16_bf16 v[16:31], v[152:155], v[172:175], v[16:31]
    ds_read_b64_tr_b16 v[148:149], v185 offset:32768
    ds_read_b64_tr_b16 v[150:151], v185 offset:33792
    ds_read_b128 v[132:135], v176 offset:36864
    v_mfma_f32_32x32x16_bf16 v[32:47], v[156:159], v[168:171], v[32:47]
    v_mfma_f32_32x32x16_bf16 v[48:63], v[156:159], v[172:175], v[48:63]
    s_waitcnt lgkmcnt(0)
    v_mfma_f32_32x32x16_bf16 v[0:15], v[128:131], v[144:147], v[0:15]
    ds_read_b64_tr_b16 v[168:169], v184 offset:36864
    ds_read_b64_tr_b16 v[170:171], v184 offset:37888
    ds_read_b128 v[152:155], v177 offset:32768
    v_mfma_f32_32x32x16_bf16 v[16:31], v[128:131], v[148:151], v[16:31]
    ds_read_b64_tr_b16 v[172:173], v185 offset:36864
    ds_read_b64_tr_b16 v[174:175], v185 offset:37888
    ds_read_b128 v[156:159], v177 offset:36864
    v_mfma_f32_32x32x16_bf16 v[32:47], v[132:135], v[144:147], v[32:47]
    v_mfma_f32_32x32x16_bf16 v[48:63], v[132:135], v[148:151], v[48:63]
    s_waitcnt lgkmcnt(0)
    v_mfma_f32_32x32x16_bf16 v[0:15], v[152:155], v[168:171], v[0:15]
    ds_read_b64_tr_b16 v[144:145], v184 offset:40960
    ds_read_b64_tr_b16 v[146:147], v184 offset:41984
    ds_read_b128 v[128:131], v178 offset:32768
    v_mfma_f32_32x32x16_bf16 v[16:31], v[152:155], v[172:175], v[16:31]
    ds_read_b64_tr_b16 v[148:149], v185 offset:40960
    ds_read_b64_tr_b16 v[150:151], v185 offset:41984
    ds_read_b128 v[132:135], v178 offset:36864
    v_mfma_f32_32x32x16_bf16 v[32:47], v[156:159], v[168:171], v[32:47]
    v_mfma_f32_32x32x16_bf16 v[48:63], v[156:159], v[172:175], v[48:63]
    s_waitcnt lgkmcnt(0)
    v_mfma_f32_32x32x16_bf16 v[0:15], v[128:131], v[144:147], v[0:15]
    ds_read_b64_tr_b16 v[168:169], v184 offset:45056
    ds_read_b64_tr_b16 v[170:171], v184 offset:46080
    ds_read_b128 v[152:155], v179 offset:32768
    v_mfma_f32_32x32x16_bf16 v[16:31], v[128:131], v[148:151], v[16:31]
    ds_read_b64_tr_b16 v[172:173], v185 offset:45056
    ds_read_b64_tr_b16 v[174:175], v185 offset:46080
    ds_read_b128 v[156:159], v179 offset:36864
    v_mfma_f32_32x32x16_bf16 v[32:47], v[132:135], v[144:147], v[32:47]
    v_mfma_f32_32x32x16_bf16 v[48:63], v[132:135], v[148:151], v[48:63]
    s_waitcnt lgkmcnt(0)
    s_barrier
    v_mfma_f32_32x32x16_bf16 v[0:15], v[152:155], v[168:171], v[0:15]
    ds_read_b64_tr_b16 v[144:145], v186 offset:0
    ds_read_b64_tr_b16 v[146:147], v186 offset:1024
    ds_read_b128 v[128:131], v180 offset:0
    v_mfma_f32_32x32x16_bf16 v[16:31], v[152:155], v[172:175], v[16:31]
    ds_read_b64_tr_b16 v[148:149], v187 offset:0
    ds_read_b64_tr_b16 v[150:151], v187 offset:1024
    ds_read_b128 v[132:135], v180 offset:4096
    v_mfma_f32_32x32x16_bf16 v[32:47], v[156:159], v[168:171], v[32:47]
    v_mfma_f32_32x32x16_bf16 v[48:63], v[156:159], v[172:175], v[48:63]
    s_waitcnt lgkmcnt(0)
    v_mfma_f32_32x32x16_bf16 v[0:15], v[128:131], v[144:147], v[0:15]
    ds_read_b64_tr_b16 v[168:169], v186 offset:4096
    ds_read_b64_tr_b16 v[170:171], v186 offset:5120
    ds_read_b128 v[152:155], v181 offset:0
    v_mfma_f32_32x32x16_bf16 v[16:31], v[128:131], v[148:151], v[16:31]
    ds_read_b64_tr_b16 v[172:173], v187 offset:4096
    ds_read_b64_tr_b16 v[174:175], v187 offset:5120
    ds_read_b128 v[156:159], v181 offset:4096
    v_mfma_f32_32x32x16_bf16 v[32:47], v[132:135], v[144:147], v[32:47]
    v_mfma_f32_32x32x16_bf16 v[48:63], v[132:135], v[148:151], v[48:63]
    s_waitcnt lgkmcnt(0)
    v_mfma_f32_32x32x16_bf16 v[0:15], v[152:155], v[168:171], v[0:15]
    ds_read_b64_tr_b16 v[144:145], v186 offset:8192
    ds_read_b64_tr_b16 v[146:147], v186 offset:9216
    ds_read_b128 v[128:131], v182 offset:0
    v_mfma_f32_32x32x16_bf16 v[16:31], v[152:155], v[172:175], v[16:31]
    ds_read_b64_tr_b16 v[148:149], v187 offset:8192
    ds_read_b64_tr_b16 v[150:151], v187 offset:9216
    ds_read_b128 v[132:135], v182 offset:4096
    v_mfma_f32_32x32x16_bf16 v[32:47], v[156:159], v[168:171], v[32:47]
    v_mfma_f32_32x32x16_bf16 v[48:63], v[156:159], v[172:175], v[48:63]
    s_waitcnt lgkmcnt(0)
    v_mfma_f32_32x32x16_bf16 v[0:15], v[128:131], v[144:147], v[0:15]
    ds_read_b64_tr_b16 v[168:169], v186 offset:12288
    ds_read_b64_tr_b16 v[170:171], v186 offset:13312
    ds_read_b128 v[152:155], v183 offset:0
    v_mfma_f32_32x32x16_bf16 v[16:31], v[128:131], v[148:151], v[16:31]
    ds_read_b64_tr_b16 v[172:173], v187 offset:12288
    ds_read_b64_tr_b16 v[174:175], v187 offset:13312
    ds_read_b128 v[156:159], v183 offset:4096
    v_mfma_f32_32x32x16_bf16 v[32:47], v[132:135], v[144:147], v[32:47]
    v_mfma_f32_32x32x16_bf16 v[48:63], v[132:135], v[148:151], v[48:63]
    s_waitcnt lgkmcnt(0)
    s_barrier
    v_mfma_f32_32x32x16_bf16 v[0:15], v[152:155], v[168:171], v[0:15]
    ds_read_b64_tr_b16 v[144:145], v184 offset:0
    ds_read_b64_tr_b16 v[146:147], v184 offset:1024
    ds_read_b128 v[128:131], v176 offset:0
    v_mfma_f32_32x32x16_bf16 v[16:31], v[152:155], v[172:175], v[16:31]
    ds_read_b64_tr_b16 v[148:149], v185 offset:0
    ds_read_b64_tr_b16 v[150:151], v185 offset:1024
    ds_read_b128 v[132:135], v176 offset:4096
    v_mfma_f32_32x32x16_bf16 v[32:47], v[156:159], v[168:171], v[32:47]
    v_mfma_f32_32x32x16_bf16 v[48:63], v[156:159], v[172:175], v[48:63]
    s_waitcnt lgkmcnt(0)
    v_mfma_f32_32x32x16_bf16 v[0:15], v[128:131], v[144:147], v[0:15]
    ds_read_b64_tr_b16 v[168:169], v184 offset:4096
    ds_read_b64_tr_b16 v[170:171], v184 offset:5120
    ds_read_b128 v[152:155], v177 offset:0
    v_mfma_f32_32x32x16_bf16 v[16:31], v[128:131], v[148:151], v[16:31]
    ds_read_b64_tr_b16 v[172:173], v185 offset:4096
    ds_read_b64_tr_b16 v[174:175], v185 offset:5120
    ds_read_b128 v[156:159], v177 offset:4096
    v_mfma_f32_32x32x16_bf16 v[32:47], v[132:135], v[144:147], v[32:47]
    v_mfma_f32_32x32x16_bf16 v[48:63], v[132:135], v[148:151], v[48:63]
    s_waitcnt lgkmcnt(0)
    v_mfma_f32_32x32x16_bf16 v[0:15], v[152:155], v[168:171], v[0:15]
    ds_read_b64_tr_b16 v[144:145], v184 offset:8192
    ds_read_b64_tr_b16 v[146:147], v184 offset:9216
    ds_read_b128 v[128:131], v178 offset:0
    v_mfma_f32_32x32x16_bf16 v[16:31], v[152:155], v[172:175], v[16:31]
    ds_read_b64_tr_b16 v[148:149], v185 offset:8192
    ds_read_b64_tr_b16 v[150:151], v185 offset:9216
    ds_read_b128 v[132:135], v178 offset:4096
    v_mfma_f32_32x32x16_bf16 v[32:47], v[156:159], v[168:171], v[32:47]
    v_mfma_f32_32x32x16_bf16 v[48:63], v[156:159], v[172:175], v[48:63]
    s_waitcnt lgkmcnt(0)
    v_mfma_f32_32x32x16_bf16 v[0:15], v[128:131], v[144:147], v[0:15]
    ds_read_b64_tr_b16 v[168:169], v184 offset:12288
    ds_read_b64_tr_b16 v[170:171], v184 offset:13312
    ds_read_b128 v[152:155], v179 offset:0
    v_mfma_f32_32x32x16_bf16 v[16:31], v[128:131], v[148:151], v[16:31]
    ds_read_b64_tr_b16 v[172:173], v185 offset:12288
    ds_read_b64_tr_b16 v[174:175], v185 offset:13312
    ds_read_b128 v[156:159], v179 offset:4096
    v_mfma_f32_32x32x16_bf16 v[32:47], v[132:135], v[144:147], v[32:47]
    v_mfma_f32_32x32x16_bf16 v[48:63], v[132:135], v[148:151], v[48:63]
    s_waitcnt lgkmcnt(0)
    s_barrier
    v_mfma_f32_32x32x16_bf16 v[0:15], v[152:155], v[168:171], v[0:15]
    ds_read_b64_tr_b16 v[144:145], v184 offset:32768
    ds_read_b64_tr_b16 v[146:147], v184 offset:33792
    ds_read_b128 v[128:131], v176 offset:32768
    v_mfma_f32_32x32x16_bf16 v[16:31], v[152:155], v[172:175], v[16:31]
    ds_read_b64_tr_b16 v[148:149], v185 offset:32768
    ds_read_b64_tr_b16 v[150:151], v185 offset:33792
    ds_read_b128 v[132:135], v176 offset:36864
    v_mfma_f32_32x32x16_bf16 v[32:47], v[156:159], v[168:171], v[32:47]
    v_mfma_f32_32x32x16_bf16 v[48:63], v[156:159], v[172:175], v[48:63]
    s_waitcnt lgkmcnt(0)
    v_mfma_f32_32x32x16_bf16 v[0:15], v[128:131], v[144:147], v[0:15]
    ds_read_b64_tr_b16 v[168:169], v184 offset:36864
    ds_read_b64_tr_b16 v[170:171], v184 offset:37888
    ds_read_b128 v[152:155], v177 offset:32768
    v_mfma_f32_32x32x16_bf16 v[16:31], v[128:131], v[148:151], v[16:31]
    ds_read_b64_tr_b16 v[172:173], v185 offset:36864
    ds_read_b64_tr_b16 v[174:175], v185 offset:37888
    ds_read_b128 v[156:159], v177 offset:36864
    v_mfma_f32_32x32x16_bf16 v[32:47], v[132:135], v[144:147], v[32:47]
    v_mfma_f32_32x32x16_bf16 v[48:63], v[132:135], v[148:151], v[48:63]
    s_waitcnt lgkmcnt(0)
    v_mfma_f32_32x32x16_bf16 v[0:15], v[152:155], v[168:171], v[0:15]
    ds_read_b64_tr_b16 v[144:145], v184 offset:40960
    ds_read_b64_tr_b16 v[146:147], v184 offset:41984
    ds_read_b128 v[128:131], v178 offset:32768
    v_mfma_f32_32x32x16_bf16 v[16:31], v[152:155], v[172:175], v[16:31]
    ds_read_b64_tr_b16 v[148:149], v185 offset:40960
    ds_read_b64_tr_b16 v[150:151], v185 offset:41984
    ds_read_b128 v[132:135], v178 offset:36864
    v_mfma_f32_32x32x16_bf16 v[32:47], v[156:159], v[168:171], v[32:47]
    v_mfma_f32_32x32x16_bf16 v[48:63], v[156:159], v[172:175], v[48:63]
    s_waitcnt lgkmcnt(0)
    v_mfma_f32_32x32x16_bf16 v[0:15], v[128:131], v[144:147], v[0:15]
    ds_read_b64_tr_b16 v[168:169], v184 offset:45056
    ds_read_b64_tr_b16 v[170:171], v184 offset:46080
    ds_read_b128 v[152:155], v179 offset:32768
    v_mfma_f32_32x32x16_bf16 v[16:31], v[128:131], v[148:151], v[16:31]
    ds_read_b64_tr_b16 v[172:173], v185 offset:45056
    ds_read_b64_tr_b16 v[174:175], v185 offset:46080
    ds_read_b128 v[156:159], v179 offset:36864
    v_mfma_f32_32x32x16_bf16 v[32:47], v[132:135], v[144:147], v[32:47]
    v_mfma_f32_32x32x16_bf16 v[48:63], v[132:135], v[148:151], v[48:63]
    s_waitcnt lgkmcnt(0)
    s_barrier
    v_mfma_f32_32x32x16_bf16 v[0:15], v[152:155], v[168:171], v[0:15]
    ds_read_b64_tr_b16 v[144:145], v186 offset:0
    ds_read_b64_tr_b16 v[146:147], v186 offset:1024
    ds_read_b128 v[128:131], v180 offset:0
    v_mfma_f32_32x32x16_bf16 v[16:31], v[152:155], v[172:175], v[16:31]
    ds_read_b64_tr_b16 v[148:149], v187 offset:0
    ds_read_b64_tr_b16 v[150:151], v187 offset:1024
    ds_read_b128 v[132:135], v180 offset:4096
    v_mfma_f32_32x32x16_bf16 v[32:47], v[156:159], v[168:171], v[32:47]
    v_mfma_f32_32x32x16_bf16 v[48:63], v[156:159], v[172:175], v[48:63]
    s_waitcnt lgkmcnt(0)
    v_mfma_f32_32x32x16_bf16 v[0:15], v[128:131], v[144:147], v[0:15]
    ds_read_b64_tr_b16 v[168:169], v186 offset:4096
    ds_read_b64_tr_b16 v[170:171], v186 offset:5120
    ds_read_b128 v[152:155], v181 offset:0
    v_mfma_f32_32x32x16_bf16 v[16:31], v[128:131], v[148:151], v[16:31]
    ds_read_b64_tr_b16 v[172:173], v187 offset:4096
    ds_read_b64_tr_b16 v[174:175], v187 offset:5120
    ds_read_b128 v[156:159], v181 offset:4096
    v_mfma_f32_32x32x16_bf16 v[32:47], v[132:135], v[144:147], v[32:47]
    v_mfma_f32_32x32x16_bf16 v[48:63], v[132:135], v[148:151], v[48:63]
    s_waitcnt lgkmcnt(0)
    v_mfma_f32_32x32x16_bf16 v[0:15], v[152:155], v[168:171], v[0:15]
    ds_read_b64_tr_b16 v[144:145], v186 offset:8192
    ds_read_b64_tr_b16 v[146:147], v186 offset:9216
    ds_read_b128 v[128:131], v182 offset:0
    v_mfma_f32_32x32x16_bf16 v[16:31], v[152:155], v[172:175], v[16:31]
    ds_read_b64_tr_b16 v[148:149], v187 offset:8192
    ds_read_b64_tr_b16 v[150:151], v187 offset:9216
    ds_read_b128 v[132:135], v182 offset:4096
    v_mfma_f32_32x32x16_bf16 v[32:47], v[156:159], v[168:171], v[32:47]
    v_mfma_f32_32x32x16_bf16 v[48:63], v[156:159], v[172:175], v[48:63]
    s_waitcnt lgkmcnt(0)
    v_mfma_f32_32x32x16_bf16 v[0:15], v[128:131], v[144:147], v[0:15]
    ds_read_b64_tr_b16 v[168:169], v186 offset:12288
    ds_read_b64_tr_b16 v[170:171], v186 offset:13312
    ds_read_b128 v[152:155], v183 offset:0
    v_mfma_f32_32x32x16_bf16 v[16:31], v[128:131], v[148:151], v[16:31]
    ds_read_b64_tr_b16 v[172:173], v187 offset:12288
    ds_read_b64_tr_b16 v[174:175], v187 offset:13312
    ds_read_b128 v[156:159], v183 offset:4096
    v_mfma_f32_32x32x16_bf16 v[32:47], v[132:135], v[144:147], v[32:47]
    v_mfma_f32_32x32x16_bf16 v[48:63], v[132:135], v[148:151], v[48:63]
    s_waitcnt lgkmcnt(0)
    s_barrier
    v_mfma_f32_32x32x16_bf16 v[0:15], v[152:155], v[168:171], v[0:15]
    ds_read_b64_tr_b16 v[144:145], v184 offset:0
    ds_read_b64_tr_b16 v[146:147], v184 offset:1024
    ds_read_b128 v[128:131], v176 offset:0
    v_mfma_f32_32x32x16_bf16 v[16:31], v[152:155], v[172:175], v[16:31]
    ds_read_b64_tr_b16 v[148:149], v185 offset:0
    ds_read_b64_tr_b16 v[150:151], v185 offset:1024
    ds_read_b128 v[132:135], v176 offset:4096
    v_mfma_f32_32x32x16_bf16 v[32:47], v[156:159], v[168:171], v[32:47]
    v_mfma_f32_32x32x16_bf16 v[48:63], v[156:159], v[172:175], v[48:63]
    s_waitcnt lgkmcnt(0)
    v_mfma_f32_32x32x16_bf16 v[0:15], v[128:131], v[144:147], v[0:15]
    ds_read_b64_tr_b16 v[168:169], v184 offset:4096
    ds_read_b64_tr_b16 v[170:171], v184 offset:5120
    ds_read_b128 v[152:155], v177 offset:0
    v_mfma_f32_32x32x16_bf16 v[16:31], v[128:131], v[148:151], v[16:31]
    ds_read_b64_tr_b16 v[172:173], v185 offset:4096
    ds_read_b64_tr_b16 v[174:175], v185 offset:5120
    ds_read_b128 v[156:159], v177 offset:4096
    v_mfma_f32_32x32x16_bf16 v[32:47], v[132:135], v[144:147], v[32:47]
    v_mfma_f32_32x32x16_bf16 v[48:63], v[132:135], v[148:151], v[48:63]
    s_waitcnt lgkmcnt(0)
    v_mfma_f32_32x32x16_bf16 v[0:15], v[152:155], v[168:171], v[0:15]
    ds_read_b64_tr_b16 v[144:145], v184 offset:8192
    ds_read_b64_tr_b16 v[146:147], v184 offset:9216
    ds_read_b128 v[128:131], v178 offset:0
    v_mfma_f32_32x32x16_bf16 v[16:31], v[152:155], v[172:175], v[16:31]
    ds_read_b64_tr_b16 v[148:149], v185 offset:8192
    ds_read_b64_tr_b16 v[150:151], v185 offset:9216
    ds_read_b128 v[132:135], v178 offset:4096
    v_mfma_f32_32x32x16_bf16 v[32:47], v[156:159], v[168:171], v[32:47]
    v_mfma_f32_32x32x16_bf16 v[48:63], v[156:159], v[172:175], v[48:63]
    s_waitcnt lgkmcnt(0)
    v_mfma_f32_32x32x16_bf16 v[0:15], v[128:131], v[144:147], v[0:15]
    ds_read_b64_tr_b16 v[168:169], v184 offset:12288
    ds_read_b64_tr_b16 v[170:171], v184 offset:13312
    ds_read_b128 v[152:155], v179 offset:0
    v_mfma_f32_32x32x16_bf16 v[16:31], v[128:131], v[148:151], v[16:31]
    ds_read_b64_tr_b16 v[172:173], v185 offset:12288
    ds_read_b64_tr_b16 v[174:175], v185 offset:13312
    ds_read_b128 v[156:159], v179 offset:4096
    v_mfma_f32_32x32x16_bf16 v[32:47], v[132:135], v[144:147], v[32:47]
    v_mfma_f32_32x32x16_bf16 v[48:63], v[132:135], v[148:151], v[48:63]
    s_waitcnt lgkmcnt(0)
    v_mfma_f32_32x32x16_bf16 v[0:15], v[152:155], v[168:171], v[0:15]
    v_mfma_f32_32x32x16_bf16 v[16:31], v[152:155], v[172:175], v[16:31]
    v_mfma_f32_32x32x16_bf16 v[32:47], v[156:159], v[168:171], v[32:47]
    v_mfma_f32_32x32x16_bf16 v[48:63], v[156:159], v[172:175], v[48:63]
    s_nop 15
    s_mul_i32 s43, s5, 2621440
    s_add_u32 s43, s43, 10485760
    s_add_u32 s44, s20, s43
    s_addc_u32 s45, s21, 0

    s_mov_b32 s48, s44
    s_and_b32 s49, s45, 0xffff
    s_mov_b32 s50, 2621440
    s_mov_b32 s51, 0x20000
    s_lshl_b32 s46, s8, 2
    s_lshl_b32 s47, s12, 1
    s_add_u32 s46, s46, s47
    s_mul_i32 s46, s46, 1280
    s_sub_u32 s42, s9, 10
    s_lshl_b32 s42, s42, 7
    s_lshl_b32 s47, s13, 6
    s_add_u32 s42, s42, s47
    v_and_b32 v130, 31, v188
    v_lshrrev_b32 v131, 5, v188
    v_mul_u32_u24 v131, 320, v131
    s_mov_b32 s52, 52429

    v_add_u32 v132, s42, v130
    v_add_u32 v132, 0, v132
    v_mul_lo_u32 v133, v132, s52
    v_lshrrev_b32 v133, 20, v133
    v_mul_u32_u24 v134, 20, v133
    v_sub_u32 v134, v132, v134
    v_lshlrev_b32 v134, 4, v134
    v_add_u32 v134, v134, v131
    v_mov_b32 v135, 81920
    v_mul_lo_u32 v133, v133, v135
    v_add_u32 v189, v133, v134

    v_add_u32 v132, s42, v130
    v_add_u32 v132, 32, v132
    v_mul_lo_u32 v133, v132, s52
    v_lshrrev_b32 v133, 20, v133
    v_mul_u32_u24 v134, 20, v133
    v_sub_u32 v134, v132, v134
    v_lshlrev_b32 v134, 4, v134
    v_add_u32 v134, v134, v131
    v_mov_b32 v135, 81920
    v_mul_lo_u32 v133, v133, v135
    v_add_u32 v190, v133, v134

    v_cvt_pk_bf16_f32 v136, v0, v1
    v_cvt_pk_bf16_f32 v137, v2, v3
    v_cvt_pk_bf16_f32 v138, v4, v5
    v_cvt_pk_bf16_f32 v139, v6, v7
    s_add_u32 s53, s46, 0
    buffer_store_dwordx4 v[136:139], v189, s[48:51], s53 offen sc1
    v_cvt_pk_bf16_f32 v140, v8, v9
    v_cvt_pk_bf16_f32 v141, v10, v11
    v_cvt_pk_bf16_f32 v142, v12, v13
    v_cvt_pk_bf16_f32 v143, v14, v15
    s_add_u32 s53, s46, 640
    buffer_store_dwordx4 v[140:143], v189, s[48:51], s53 offen sc1
    v_cvt_pk_bf16_f32 v144, v16, v17
    v_cvt_pk_bf16_f32 v145, v18, v19
    v_cvt_pk_bf16_f32 v146, v20, v21
    v_cvt_pk_bf16_f32 v147, v22, v23
    s_add_u32 s53, s46, 0
    buffer_store_dwordx4 v[144:147], v190, s[48:51], s53 offen sc1
    v_cvt_pk_bf16_f32 v148, v24, v25
    v_cvt_pk_bf16_f32 v149, v26, v27
    v_cvt_pk_bf16_f32 v150, v28, v29
    v_cvt_pk_bf16_f32 v151, v30, v31
    s_add_u32 s53, s46, 640
    buffer_store_dwordx4 v[148:151], v190, s[48:51], s53 offen sc1
    v_cvt_pk_bf16_f32 v136, v32, v33
    v_cvt_pk_bf16_f32 v137, v34, v35
    v_cvt_pk_bf16_f32 v138, v36, v37
    v_cvt_pk_bf16_f32 v139, v38, v39
    s_add_u32 s53, s46, 1280
    buffer_store_dwordx4 v[136:139], v189, s[48:51], s53 offen sc1
    v_cvt_pk_bf16_f32 v140, v40, v41
    v_cvt_pk_bf16_f32 v141, v42, v43
    v_cvt_pk_bf16_f32 v142, v44, v45
    v_cvt_pk_bf16_f32 v143, v46, v47
    s_add_u32 s53, s46, 1920
    buffer_store_dwordx4 v[140:143], v189, s[48:51], s53 offen sc1
    v_cvt_pk_bf16_f32 v144, v48, v49
    v_cvt_pk_bf16_f32 v145, v50, v51
    v_cvt_pk_bf16_f32 v146, v52, v53
    v_cvt_pk_bf16_f32 v147, v54, v55
    s_add_u32 s53, s46, 1280
    buffer_store_dwordx4 v[144:147], v190, s[48:51], s53 offen sc1
    v_cvt_pk_bf16_f32 v148, v56, v57
    v_cvt_pk_bf16_f32 v149, v58, v59
    v_cvt_pk_bf16_f32 v150, v60, v61
    v_cvt_pk_bf16_f32 v151, v62, v63
    s_add_u32 s53, s46, 1920
    buffer_store_dwordx4 v[148:151], v190, s[48:51], s53 offen sc1
K1_END:
    s_endpgm
    .globl k2_attn_kernel
    .p2align 8
    .type k2_attn_kernel,@function
k2_attn_kernel:
    s_cmp_ge_u32 s2, 256
    s_cbranch_scc1 K2_END
    s_load_dwordx2 s[20:21], s[0:1], 64
    s_load_dwordx4 s[76:79], s[0:1], 24

    s_and_b32 s3, s2, 7
    s_lshr_b32 s4, s2, 3
    s_and_b32 s5, s4, 3
    s_lshl_b32 s6, s3, 2
    s_add_u32 s5, s5, s6
    s_lshr_b32 s6, s4, 2
    v_lshrrev_b32 v2, 6, v0
    v_and_b32 v1, 63, v0
    s_mul_i32 s16, s5, 81920
    v_readfirstlane_b32 s7, v2
    v_lshlrev_b32 v10, 4, v1
    s_and_b32 s17, s3, 3
    s_lshl_b32 s17, s17, 2
    s_and_b32 s18, s4, 3
    s_add_u32 s17, s17, s18
    s_lshr_b32 s18, s3, 2
    s_lshl_b32 s18, s18, 3
    s_add_u32 s18, s18, s6
    s_cmp_ge_u32 s7, 8
    s_cbranch_scc0 K2_COMPUTE
    s_cmp_ge_u32 s7, 12
    s_cbranch_scc0 K2_GEMM

    s_setprio 3
    s_lshr_b32 s9, s5, 1
    s_and_b32 s10, s5, 1
    s_mul_i32 s11, s9, 5
    s_mul_i32 s12, s10, 3
    s_add_u32 s12, s12, s11
    s_lshl_b32 s12, s12, 9
    s_add_u32 s13, s11, 2
    s_lshl_b32 s13, s13, 9
    s_lshl_b32 s14, s10, 3
    s_add_u32 s13, s13, s14

    s_sub_u32 s7, s7, 12
    v_lshrrev_b32 v2, 1, v1
    v_lshlrev_b32 v2, 4, v2
    v_and_b32 v3, 1, v1
    v_lshlrev_b32 v3, 2, v3
    v_add_u32 v2, v2, v3
    s_mul_i32 s65, s7, 40960
    s_add_u32 s66, s65, s13
    s_add_u32 s65, s65, s12
    s_lshl_b32 s67, s7, 10
    s_lshl_b32 s69, s7, 8
    s_add_u32 s68, s67, s16
    s_add_u32 s70, s69, s16
    s_mov_b64 s[60:61], 0xffff
    s_waitcnt lgkmcnt(0)

    s_add_u32 s22, s20, 2621440
    s_addc_u32 s23, s21, 0
    s_mov_b32 s28, s22
    s_and_b32 s29, s23, 0xffff
    s_mov_b32 s30, 2621440
    s_mov_b32 s31, 0x20000
    s_add_u32 s22, s20, 10485760
    s_addc_u32 s23, s21, 0
    s_mov_b32 s32, s22
    s_and_b32 s33, s23, 0xffff
    s_mov_b32 s34, 2621440
    s_mov_b32 s35, 0x20000
    s_add_u32 m0, s67, 0
    s_add_u32 s62, s65, 0
    buffer_load_dwordx4 v10, s[28:31], s62 offen lds
    s_add_u32 m0, s69, 4096
    s_add_u32 s62, s66, 0
    buffer_load_dword v2, s[28:31], s62 offen lds
    s_add_u32 m0, s67, 5120
    s_add_u32 s62, s68, 0
    buffer_load_dwordx4 v10, s[32:35], s62 offen lds
    s_add_u32 m0, s69, 9216
    s_add_u32 s62, s70, 4096
    s_mov_b64 exec, s[60:61]
    buffer_load_dwordx4 v10, s[32:35], s62 offen lds
    s_mov_b64 exec, -1
    s_add_u32 m0, s67, 10240
    s_add_u32 s62, s65, 163840
    buffer_load_dwordx4 v10, s[28:31], s62 offen lds
    s_add_u32 m0, s69, 14336
    s_add_u32 s62, s66, 163840
    buffer_load_dword v2, s[28:31], s62 offen lds
    s_add_u32 m0, s67, 15360
    s_add_u32 s62, s68, 5120
    buffer_load_dwordx4 v10, s[32:35], s62 offen lds
    s_add_u32 m0, s69, 19456
    s_add_u32 s62, s70, 9216
    s_mov_b64 exec, s[60:61]
    buffer_load_dwordx4 v10, s[32:35], s62 offen lds
    s_mov_b64 exec, -1
    v_lshrrev_b32 v3, 3, v1
    v_mul_u32_u24 v4, 1280, v3
    v_lshrrev_b32 v5, 4, v1
    s_and_b32 s24, s7, 1
    s_lshl_b32 s24, s24, 2
    v_add_u32 v6, s24, v5
    v_and_b32 v7, 7, v1
    v_xor_b32 v7, v7, v6
    v_lshl_add_u32 v12, v7, 4, v4
    v_lshlrev_b32 v6, 2, v5
    v_and_b32 v7, 15, v1
    v_xor_b32 v7, v7, v6
    v_min_u32 v7, 14, v7
    v_mul_u32_u24 v8, 205, v7
    v_lshrrev_b32 v8, 10, v8
    v_mul_u32_u24 v9, 5, v8
    v_sub_u32 v9, v7, v9
    v_mul_u32_u24 v8, 1280, v8
    v_lshl_add_u32 v8, v9, 4, v8
    v_mul_u32_u24 v4, 3840, v5
    v_add_u32 v13, v4, v8
    s_lshl_b32 s25, s18, 7
    s_sub_u32 s26, s25, 32
    s_max_i32 s26, s26, 0
    s_lshl_b32 s27, s7, 3
    s_add_u32 s26, s26, s27
    s_mul_i32 s73, s26, 1280
    s_add_u32 s25, s25, s27
    s_mul_i32 s74, s25, 1280
    s_mul_i32 s75, s7, 15360
    s_mul_i32 s27, s17, 80
    s_add_u32 s75, s75, s27

    s_mov_b32 s40, s76
    s_and_b32 s41, s77, 0xffff
    s_mov_b32 s42, 2621440
    s_mov_b32 s43, 0x20000
    s_mov_b32 s44, s78
    s_and_b32 s45, s79, 0xffff
    s_mov_b32 s46, 2457600
    s_mov_b32 s47, 0x20000
    s_add_u32 s71, s4, s6
    s_and_b32 s71, s71, 3
    s_lshl_b32 s71, s71, 2
    s_lshr_b32 s71, 0, s71
    s_and_b32 s71, s71, 15
    s_mul_i32 s72, s71, 245760
    s_lshl_b32 s71, s71, 7
    s_cmp_lt_u32 s7, 0
    s_cselect_b32 s24, 0x70000000, 0
    v_add_u32 v14, s24, v12

    s_waitcnt vmcnt(4)
    s_barrier
    s_add_u32 m0, s67, 20480
    s_add_u32 s62, s65, 327680
    buffer_load_dwordx4 v10, s[28:31], s62 offen lds
    s_add_u32 m0, s69, 24576
    s_add_u32 s62, s66, 327680
    buffer_load_dword v2, s[28:31], s62 offen lds
    s_add_u32 m0, s67, 25600
    s_add_u32 s62, s68, 10240
    buffer_load_dwordx4 v10, s[32:35], s62 offen lds
    s_add_u32 m0, s69, 29696
    s_add_u32 s62, s70, 14336
    s_mov_b64 exec, s[60:61]
    buffer_load_dwordx4 v10, s[32:35], s62 offen lds
    s_mov_b64 exec, -1
    s_add_u32 s63, s74, s71
    s_add_u32 s64, s75, s72
    s_add_u32 m0, s67, 40960
    s_add_u32 s62, s73, s71
    buffer_load_dwordx4 v14, s[40:43], s62 offen lds
    s_add_u32 m0, s67, 45056
    s_add_u32 s62, s63, 0
    buffer_load_dwordx4 v12, s[40:43], s62 offen lds
    s_add_u32 m0, s67, 49152
    s_add_u32 s62, s63, 40960
    buffer_load_dwordx4 v12, s[40:43], s62 offen lds
    s_add_u32 m0, s67, 53248
    s_add_u32 s62, s63, 81920
    buffer_load_dwordx4 v12, s[40:43], s62 offen lds
    s_add_u32 m0, s67, 57344
    s_add_u32 s62, s63, 122880
    buffer_load_dwordx4 v12, s[40:43], s62 offen lds
    s_add_u32 m0, s67, 61440
    s_add_u32 s62, s64, 0
    buffer_load_dwordx4 v13, s[44:47], s62 offen lds
    s_add_u32 m0, s67, 65536
    s_add_u32 s62, s64, 61440
    buffer_load_dwordx4 v13, s[44:47], s62 offen lds
    s_add_u32 m0, s67, 69632
    s_add_u32 s62, s64, 122880
    buffer_load_dwordx4 v13, s[44:47], s62 offen lds
    s_add_u32 m0, s67, 73728
    s_add_u32 s62, s64, 184320
    buffer_load_dwordx4 v13, s[44:47], s62 offen lds
    s_add_u32 s71, s71, 128
    s_add_u32 s72, s72, 245760
    s_cmp_eq_u32 s71, 1280
    s_cselect_b32 s71, 0, s71
    s_cselect_b32 s72, 0, s72

    s_waitcnt vmcnt(13)
    s_barrier
    s_add_u32 m0, s67, 30720
    s_add_u32 s62, s65, 491520
    buffer_load_dwordx4 v10, s[28:31], s62 offen lds
    s_add_u32 m0, s69, 34816
    s_add_u32 s62, s66, 491520
    buffer_load_dword v2, s[28:31], s62 offen lds
    s_add_u32 m0, s67, 35840
    s_add_u32 s62, s68, 15360
    buffer_load_dwordx4 v10, s[32:35], s62 offen lds
    s_add_u32 m0, s69, 39936
    s_add_u32 s62, s70, 19456
    s_mov_b64 exec, s[60:61]
    buffer_load_dwordx4 v10, s[32:35], s62 offen lds
    s_mov_b64 exec, -1
    s_add_u32 s63, s74, s71
    s_add_u32 s64, s75, s72
    s_add_u32 m0, s67, 77824
    s_add_u32 s62, s73, s71
    buffer_load_dwordx4 v14, s[40:43], s62 offen lds
    s_add_u32 m0, s67, 81920
    s_add_u32 s62, s63, 0
    buffer_load_dwordx4 v12, s[40:43], s62 offen lds
    s_add_u32 m0, s67, 86016
    s_add_u32 s62, s63, 40960
    buffer_load_dwordx4 v12, s[40:43], s62 offen lds
    s_add_u32 m0, s67, 90112
    s_add_u32 s62, s63, 81920
    buffer_load_dwordx4 v12, s[40:43], s62 offen lds
    s_add_u32 m0, s67, 94208
    s_add_u32 s62, s63, 122880
    buffer_load_dwordx4 v12, s[40:43], s62 offen lds
    s_add_u32 m0, s67, 98304
    s_add_u32 s62, s64, 0
    buffer_load_dwordx4 v13, s[44:47], s62 offen lds
    s_add_u32 m0, s67, 102400
    s_add_u32 s62, s64, 61440
    buffer_load_dwordx4 v13, s[44:47], s62 offen lds
    s_add_u32 m0, s67, 106496
    s_add_u32 s62, s64, 122880
    buffer_load_dwordx4 v13, s[44:47], s62 offen lds
    s_add_u32 m0, s67, 110592
    s_add_u32 s62, s64, 184320
    buffer_load_dwordx4 v13, s[44:47], s62 offen lds
    s_add_u32 s71, s71, 128
    s_add_u32 s72, s72, 245760
    s_cmp_eq_u32 s71, 1280
    s_cselect_b32 s71, 0, s71
    s_cselect_b32 s72, 0, s72

    s_waitcnt vmcnt(13)
    s_barrier
    s_add_u32 m0, s67, 0
    s_add_u32 s62, s65, 655360
    buffer_load_dwordx4 v10, s[28:31], s62 offen lds
    s_add_u32 m0, s69, 4096
    s_add_u32 s62, s66, 655360
    buffer_load_dword v2, s[28:31], s62 offen lds
    s_add_u32 m0, s67, 5120
    s_add_u32 s62, s68, 20480
    buffer_load_dwordx4 v10, s[32:35], s62 offen lds
    s_add_u32 m0, s69, 9216
    s_add_u32 s62, s70, 24576
    s_mov_b64 exec, s[60:61]
    buffer_load_dwordx4 v10, s[32:35], s62 offen lds
    s_mov_b64 exec, -1
    s_add_u32 s63, s74, s71
    s_add_u32 s64, s75, s72
    s_add_u32 m0, s67, 114688
    s_add_u32 s62, s73, s71
    buffer_load_dwordx4 v14, s[40:43], s62 offen lds
    s_add_u32 m0, s67, 118784
    s_add_u32 s62, s63, 0
    buffer_load_dwordx4 v12, s[40:43], s62 offen lds
    s_add_u32 m0, s67, 122880
    s_add_u32 s62, s63, 40960
    buffer_load_dwordx4 v12, s[40:43], s62 offen lds
    s_add_u32 m0, s67, 126976
    s_add_u32 s62, s63, 81920
    buffer_load_dwordx4 v12, s[40:43], s62 offen lds
    s_add_u32 m0, s67, 131072
    s_add_u32 s62, s63, 122880
    buffer_load_dwordx4 v12, s[40:43], s62 offen lds
    s_add_u32 m0, s67, 135168
    s_add_u32 s62, s64, 0
    buffer_load_dwordx4 v13, s[44:47], s62 offen lds
    s_add_u32 m0, s67, 139264
    s_add_u32 s62, s64, 61440
    buffer_load_dwordx4 v13, s[44:47], s62 offen lds
    s_add_u32 m0, s67, 143360
    s_add_u32 s62, s64, 122880
    buffer_load_dwordx4 v13, s[44:47], s62 offen lds
    s_add_u32 m0, s67, 147456
    s_add_u32 s62, s64, 184320
    buffer_load_dwordx4 v13, s[44:47], s62 offen lds
    s_add_u32 s71, s71, 128
    s_add_u32 s72, s72, 245760
    s_cmp_eq_u32 s71, 1280
    s_cselect_b32 s71, 0, s71
    s_cselect_b32 s72, 0, s72

    s_waitcnt vmcnt(13)
    s_barrier
    s_add_u32 m0, s67, 10240
    s_add_u32 s62, s65, 819200
    buffer_load_dwordx4 v10, s[28:31], s62 offen lds
    s_add_u32 m0, s69, 14336
    s_add_u32 s62, s66, 819200
    buffer_load_dword v2, s[28:31], s62 offen lds
    s_add_u32 m0, s67, 15360
    s_add_u32 s62, s68, 25600
    buffer_load_dwordx4 v10, s[32:35], s62 offen lds
    s_add_u32 m0, s69, 19456
    s_add_u32 s62, s70, 29696
    s_mov_b64 exec, s[60:61]
    buffer_load_dwordx4 v10, s[32:35], s62 offen lds
    s_mov_b64 exec, -1
    s_add_u32 s63, s74, s71
    s_add_u32 s64, s75, s72
    s_add_u32 m0, s67, 40960
    s_add_u32 s62, s73, s71
    buffer_load_dwordx4 v14, s[40:43], s62 offen lds
    s_add_u32 m0, s67, 45056
    s_add_u32 s62, s63, 0
    buffer_load_dwordx4 v12, s[40:43], s62 offen lds
    s_add_u32 m0, s67, 49152
    s_add_u32 s62, s63, 40960
    buffer_load_dwordx4 v12, s[40:43], s62 offen lds
    s_add_u32 m0, s67, 53248
    s_add_u32 s62, s63, 81920
    buffer_load_dwordx4 v12, s[40:43], s62 offen lds
    s_add_u32 m0, s67, 57344
    s_add_u32 s62, s63, 122880
    buffer_load_dwordx4 v12, s[40:43], s62 offen lds
    s_add_u32 m0, s67, 61440
    s_add_u32 s62, s64, 0
    buffer_load_dwordx4 v13, s[44:47], s62 offen lds
    s_add_u32 m0, s67, 65536
    s_add_u32 s62, s64, 61440
    buffer_load_dwordx4 v13, s[44:47], s62 offen lds
    s_add_u32 m0, s67, 69632
    s_add_u32 s62, s64, 122880
    buffer_load_dwordx4 v13, s[44:47], s62 offen lds
    s_add_u32 m0, s67, 73728
    s_add_u32 s62, s64, 184320
    buffer_load_dwordx4 v13, s[44:47], s62 offen lds
    s_add_u32 s71, s71, 128
    s_add_u32 s72, s72, 245760
    s_cmp_eq_u32 s71, 1280
    s_cselect_b32 s71, 0, s71
    s_cselect_b32 s72, 0, s72

    s_waitcnt vmcnt(13)
    s_barrier
    s_add_u32 m0, s67, 20480
    s_add_u32 s62, s65, 983040
    buffer_load_dwordx4 v10, s[28:31], s62 offen lds
    s_add_u32 m0, s69, 24576
    s_add_u32 s62, s66, 983040
    buffer_load_dword v2, s[28:31], s62 offen lds
    s_add_u32 m0, s67, 25600
    s_add_u32 s62, s68, 30720
    buffer_load_dwordx4 v10, s[32:35], s62 offen lds
    s_add_u32 m0, s69, 29696
    s_add_u32 s62, s70, 34816
    s_mov_b64 exec, s[60:61]
    buffer_load_dwordx4 v10, s[32:35], s62 offen lds
    s_mov_b64 exec, -1
    s_add_u32 s63, s74, s71
    s_add_u32 s64, s75, s72
    s_add_u32 m0, s67, 77824
    s_add_u32 s62, s73, s71
    buffer_load_dwordx4 v14, s[40:43], s62 offen lds
    s_add_u32 m0, s67, 81920
    s_add_u32 s62, s63, 0
    buffer_load_dwordx4 v12, s[40:43], s62 offen lds
    s_add_u32 m0, s67, 86016
    s_add_u32 s62, s63, 40960
    buffer_load_dwordx4 v12, s[40:43], s62 offen lds
    s_add_u32 m0, s67, 90112
    s_add_u32 s62, s63, 81920
    buffer_load_dwordx4 v12, s[40:43], s62 offen lds
    s_add_u32 m0, s67, 94208
    s_add_u32 s62, s63, 122880
    buffer_load_dwordx4 v12, s[40:43], s62 offen lds
    s_add_u32 m0, s67, 98304
    s_add_u32 s62, s64, 0
    buffer_load_dwordx4 v13, s[44:47], s62 offen lds
    s_add_u32 m0, s67, 102400
    s_add_u32 s62, s64, 61440
    buffer_load_dwordx4 v13, s[44:47], s62 offen lds
    s_add_u32 m0, s67, 106496
    s_add_u32 s62, s64, 122880
    buffer_load_dwordx4 v13, s[44:47], s62 offen lds
    s_add_u32 m0, s67, 110592
    s_add_u32 s62, s64, 184320
    buffer_load_dwordx4 v13, s[44:47], s62 offen lds
    s_add_u32 s71, s71, 128
    s_add_u32 s72, s72, 245760
    s_cmp_eq_u32 s71, 1280
    s_cselect_b32 s71, 0, s71
    s_cselect_b32 s72, 0, s72

    s_waitcnt vmcnt(13)
    s_barrier
    s_add_u32 m0, s67, 30720
    s_add_u32 s62, s65, 1146880
    buffer_load_dwordx4 v10, s[28:31], s62 offen lds
    s_add_u32 m0, s69, 34816
    s_add_u32 s62, s66, 1146880
    buffer_load_dword v2, s[28:31], s62 offen lds
    s_add_u32 m0, s67, 35840
    s_add_u32 s62, s68, 35840
    buffer_load_dwordx4 v10, s[32:35], s62 offen lds
    s_add_u32 m0, s69, 39936
    s_add_u32 s62, s70, 39936
    s_mov_b64 exec, s[60:61]
    buffer_load_dwordx4 v10, s[32:35], s62 offen lds
    s_mov_b64 exec, -1
    s_add_u32 s63, s74, s71
    s_add_u32 s64, s75, s72
    s_add_u32 m0, s67, 114688
    s_add_u32 s62, s73, s71
    buffer_load_dwordx4 v14, s[40:43], s62 offen lds
    s_add_u32 m0, s67, 118784
    s_add_u32 s62, s63, 0
    buffer_load_dwordx4 v12, s[40:43], s62 offen lds
    s_add_u32 m0, s67, 122880
    s_add_u32 s62, s63, 40960
    buffer_load_dwordx4 v12, s[40:43], s62 offen lds
    s_add_u32 m0, s67, 126976
    s_add_u32 s62, s63, 81920
    buffer_load_dwordx4 v12, s[40:43], s62 offen lds
    s_add_u32 m0, s67, 131072
    s_add_u32 s62, s63, 122880
    buffer_load_dwordx4 v12, s[40:43], s62 offen lds
    s_add_u32 m0, s67, 135168
    s_add_u32 s62, s64, 0
    buffer_load_dwordx4 v13, s[44:47], s62 offen lds
    s_add_u32 m0, s67, 139264
    s_add_u32 s62, s64, 61440
    buffer_load_dwordx4 v13, s[44:47], s62 offen lds
    s_add_u32 m0, s67, 143360
    s_add_u32 s62, s64, 122880
    buffer_load_dwordx4 v13, s[44:47], s62 offen lds
    s_add_u32 m0, s67, 147456
    s_add_u32 s62, s64, 184320
    buffer_load_dwordx4 v13, s[44:47], s62 offen lds
    s_add_u32 s71, s71, 128
    s_add_u32 s72, s72, 245760
    s_cmp_eq_u32 s71, 1280
    s_cselect_b32 s71, 0, s71
    s_cselect_b32 s72, 0, s72

    s_waitcnt vmcnt(13)
    s_barrier
    s_add_u32 m0, s67, 0
    s_add_u32 s62, s65, 1310720
    buffer_load_dwordx4 v10, s[28:31], s62 offen lds
    s_add_u32 m0, s69, 4096
    s_add_u32 s62, s66, 1310720
    buffer_load_dword v2, s[28:31], s62 offen lds
    s_add_u32 m0, s67, 5120
    s_add_u32 s62, s68, 40960
    buffer_load_dwordx4 v10, s[32:35], s62 offen lds
    s_add_u32 m0, s69, 9216
    s_add_u32 s62, s70, 45056
    s_mov_b64 exec, s[60:61]
    buffer_load_dwordx4 v10, s[32:35], s62 offen lds
    s_mov_b64 exec, -1
    s_add_u32 s63, s74, s71
    s_add_u32 s64, s75, s72
    s_add_u32 m0, s67, 40960
    s_add_u32 s62, s73, s71
    buffer_load_dwordx4 v14, s[40:43], s62 offen lds
    s_add_u32 m0, s67, 45056
    s_add_u32 s62, s63, 0
    buffer_load_dwordx4 v12, s[40:43], s62 offen lds
    s_add_u32 m0, s67, 49152
    s_add_u32 s62, s63, 40960
    buffer_load_dwordx4 v12, s[40:43], s62 offen lds
    s_add_u32 m0, s67, 53248
    s_add_u32 s62, s63, 81920
    buffer_load_dwordx4 v12, s[40:43], s62 offen lds
    s_add_u32 m0, s67, 57344
    s_add_u32 s62, s63, 122880
    buffer_load_dwordx4 v12, s[40:43], s62 offen lds
    s_add_u32 m0, s67, 61440
    s_add_u32 s62, s64, 0
    buffer_load_dwordx4 v13, s[44:47], s62 offen lds
    s_add_u32 m0, s67, 65536
    s_add_u32 s62, s64, 61440
    buffer_load_dwordx4 v13, s[44:47], s62 offen lds
    s_add_u32 m0, s67, 69632
    s_add_u32 s62, s64, 122880
    buffer_load_dwordx4 v13, s[44:47], s62 offen lds
    s_add_u32 m0, s67, 73728
    s_add_u32 s62, s64, 184320
    buffer_load_dwordx4 v13, s[44:47], s62 offen lds
    s_add_u32 s71, s71, 128
    s_add_u32 s72, s72, 245760
    s_cmp_eq_u32 s71, 1280
    s_cselect_b32 s71, 0, s71
    s_cselect_b32 s72, 0, s72

    s_waitcnt vmcnt(13)
    s_barrier
    s_add_u32 m0, s67, 10240
    s_add_u32 s62, s65, 1474560
    buffer_load_dwordx4 v10, s[28:31], s62 offen lds
    s_add_u32 m0, s69, 14336
    s_add_u32 s62, s66, 1474560
    buffer_load_dword v2, s[28:31], s62 offen lds
    s_add_u32 m0, s67, 15360
    s_add_u32 s62, s68, 46080
    buffer_load_dwordx4 v10, s[32:35], s62 offen lds
    s_add_u32 m0, s69, 19456
    s_add_u32 s62, s70, 50176
    s_mov_b64 exec, s[60:61]
    buffer_load_dwordx4 v10, s[32:35], s62 offen lds
    s_mov_b64 exec, -1
    s_add_u32 s63, s74, s71
    s_add_u32 s64, s75, s72
    s_add_u32 m0, s67, 77824
    s_add_u32 s62, s73, s71
    buffer_load_dwordx4 v14, s[40:43], s62 offen lds
    s_add_u32 m0, s67, 81920
    s_add_u32 s62, s63, 0
    buffer_load_dwordx4 v12, s[40:43], s62 offen lds
    s_add_u32 m0, s67, 86016
    s_add_u32 s62, s63, 40960
    buffer_load_dwordx4 v12, s[40:43], s62 offen lds
    s_add_u32 m0, s67, 90112
    s_add_u32 s62, s63, 81920
    buffer_load_dwordx4 v12, s[40:43], s62 offen lds
    s_add_u32 m0, s67, 94208
    s_add_u32 s62, s63, 122880
    buffer_load_dwordx4 v12, s[40:43], s62 offen lds
    s_add_u32 m0, s67, 98304
    s_add_u32 s62, s64, 0
    buffer_load_dwordx4 v13, s[44:47], s62 offen lds
    s_add_u32 m0, s67, 102400
    s_add_u32 s62, s64, 61440
    buffer_load_dwordx4 v13, s[44:47], s62 offen lds
    s_add_u32 m0, s67, 106496
    s_add_u32 s62, s64, 122880
    buffer_load_dwordx4 v13, s[44:47], s62 offen lds
    s_add_u32 m0, s67, 110592
    s_add_u32 s62, s64, 184320
    buffer_load_dwordx4 v13, s[44:47], s62 offen lds
    s_add_u32 s71, s71, 128
    s_add_u32 s72, s72, 245760
    s_cmp_eq_u32 s71, 1280
    s_cselect_b32 s71, 0, s71
    s_cselect_b32 s72, 0, s72

    s_waitcnt vmcnt(13)
    s_barrier
    s_add_u32 m0, s67, 20480
    s_add_u32 s62, s65, 1638400
    buffer_load_dwordx4 v10, s[28:31], s62 offen lds
    s_add_u32 m0, s69, 24576
    s_add_u32 s62, s66, 1638400
    buffer_load_dword v2, s[28:31], s62 offen lds
    s_add_u32 m0, s67, 25600
    s_add_u32 s62, s68, 51200
    buffer_load_dwordx4 v10, s[32:35], s62 offen lds
    s_add_u32 m0, s69, 29696
    s_add_u32 s62, s70, 55296
    s_mov_b64 exec, s[60:61]
    buffer_load_dwordx4 v10, s[32:35], s62 offen lds
    s_mov_b64 exec, -1
    s_add_u32 s63, s74, s71
    s_add_u32 s64, s75, s72
    s_add_u32 m0, s67, 114688
    s_add_u32 s62, s73, s71
    buffer_load_dwordx4 v14, s[40:43], s62 offen lds
    s_add_u32 m0, s67, 118784
    s_add_u32 s62, s63, 0
    buffer_load_dwordx4 v12, s[40:43], s62 offen lds
    s_add_u32 m0, s67, 122880
    s_add_u32 s62, s63, 40960
    buffer_load_dwordx4 v12, s[40:43], s62 offen lds
    s_add_u32 m0, s67, 126976
    s_add_u32 s62, s63, 81920
    buffer_load_dwordx4 v12, s[40:43], s62 offen lds
    s_add_u32 m0, s67, 131072
    s_add_u32 s62, s63, 122880
    buffer_load_dwordx4 v12, s[40:43], s62 offen lds
    s_add_u32 m0, s67, 135168
    s_add_u32 s62, s64, 0
    buffer_load_dwordx4 v13, s[44:47], s62 offen lds
    s_add_u32 m0, s67, 139264
    s_add_u32 s62, s64, 61440
    buffer_load_dwordx4 v13, s[44:47], s62 offen lds
    s_add_u32 m0, s67, 143360
    s_add_u32 s62, s64, 122880
    buffer_load_dwordx4 v13, s[44:47], s62 offen lds
    s_add_u32 m0, s67, 147456
    s_add_u32 s62, s64, 184320
    buffer_load_dwordx4 v13, s[44:47], s62 offen lds
    s_add_u32 s71, s71, 128
    s_add_u32 s72, s72, 245760
    s_cmp_eq_u32 s71, 1280
    s_cselect_b32 s71, 0, s71
    s_cselect_b32 s72, 0, s72

    s_waitcnt vmcnt(13)
    s_barrier
    s_add_u32 m0, s67, 30720
    s_add_u32 s62, s65, 1802240
    buffer_load_dwordx4 v10, s[28:31], s62 offen lds
    s_add_u32 m0, s69, 34816
    s_add_u32 s62, s66, 1802240
    buffer_load_dword v2, s[28:31], s62 offen lds
    s_add_u32 m0, s67, 35840
    s_add_u32 s62, s68, 56320
    buffer_load_dwordx4 v10, s[32:35], s62 offen lds
    s_add_u32 m0, s69, 39936
    s_add_u32 s62, s70, 60416
    s_mov_b64 exec, s[60:61]
    buffer_load_dwordx4 v10, s[32:35], s62 offen lds
    s_mov_b64 exec, -1
    s_add_u32 s63, s74, s71
    s_add_u32 s64, s75, s72
    s_add_u32 m0, s67, 40960
    s_add_u32 s62, s73, s71
    buffer_load_dwordx4 v14, s[40:43], s62 offen lds
    s_add_u32 m0, s67, 45056
    s_add_u32 s62, s63, 0
    buffer_load_dwordx4 v12, s[40:43], s62 offen lds
    s_add_u32 m0, s67, 49152
    s_add_u32 s62, s63, 40960
    buffer_load_dwordx4 v12, s[40:43], s62 offen lds
    s_add_u32 m0, s67, 53248
    s_add_u32 s62, s63, 81920
    buffer_load_dwordx4 v12, s[40:43], s62 offen lds
    s_add_u32 m0, s67, 57344
    s_add_u32 s62, s63, 122880
    buffer_load_dwordx4 v12, s[40:43], s62 offen lds
    s_add_u32 m0, s67, 61440
    s_add_u32 s62, s64, 0
    buffer_load_dwordx4 v13, s[44:47], s62 offen lds
    s_add_u32 m0, s67, 65536
    s_add_u32 s62, s64, 61440
    buffer_load_dwordx4 v13, s[44:47], s62 offen lds
    s_add_u32 m0, s67, 69632
    s_add_u32 s62, s64, 122880
    buffer_load_dwordx4 v13, s[44:47], s62 offen lds
    s_add_u32 m0, s67, 73728
    s_add_u32 s62, s64, 184320
    buffer_load_dwordx4 v13, s[44:47], s62 offen lds
    s_add_u32 s71, s71, 128
    s_add_u32 s72, s72, 245760
    s_cmp_eq_u32 s71, 1280
    s_cselect_b32 s71, 0, s71
    s_cselect_b32 s72, 0, s72

    s_waitcnt vmcnt(13)
    s_barrier
    s_add_u32 m0, s67, 0
    s_add_u32 s62, s65, 1966080
    buffer_load_dwordx4 v10, s[28:31], s62 offen lds
    s_add_u32 m0, s69, 4096
    s_add_u32 s62, s66, 1966080
    buffer_load_dword v2, s[28:31], s62 offen lds
    s_add_u32 m0, s67, 5120
    s_add_u32 s62, s68, 61440
    buffer_load_dwordx4 v10, s[32:35], s62 offen lds
    s_add_u32 m0, s69, 9216
    s_add_u32 s62, s70, 65536
    s_mov_b64 exec, s[60:61]
    buffer_load_dwordx4 v10, s[32:35], s62 offen lds
    s_mov_b64 exec, -1
    s_load_dwordx2 s[44:45], s[0:1], 16
    s_load_dwordx2 s[46:47], s[0:1], 40
    s_waitcnt vmcnt(4)
    s_barrier
    s_add_u32 m0, s67, 10240
    s_add_u32 s62, s65, 2129920
    buffer_load_dwordx4 v10, s[28:31], s62 offen lds
    s_add_u32 m0, s69, 14336
    s_add_u32 s62, s66, 2129920
    buffer_load_dword v2, s[28:31], s62 offen lds
    s_add_u32 m0, s67, 15360
    s_add_u32 s62, s68, 66560
    buffer_load_dwordx4 v10, s[32:35], s62 offen lds
    s_add_u32 m0, s69, 19456
    s_add_u32 s62, s70, 70656
    s_mov_b64 exec, s[60:61]
    buffer_load_dwordx4 v10, s[32:35], s62 offen lds
    s_mov_b64 exec, -1
    s_waitcnt lgkmcnt(0)
    s_add_u32 s22, s20, 20971520
    s_addc_u32 s23, s21, 0

    s_mov_b32 s36, s22
    s_and_b32 s37, s23, 0xffff
    s_mov_b32 s38, 1638400
    s_mov_b32 s39, 0x20000
    v_lshrrev_b32 v4, 4, v1
    v_and_b32 v5, 15, v1

    s_lshl_b32 s50, s2, 2
    s_add_u32 s50, s50, s7
    s_mov_b32 s40, s50
    s_mul_i32 s41, s40, 5243
    s_lshr_b32 s41, s41, 19
    s_mul_i32 s42, s41, 100
    s_sub_u32 s42, s40, s42
    s_mul_i32 s43, s42, 205
    s_lshr_b32 s43, s43, 10
    s_mul_i32 s48, s43, 5
    s_sub_u32 s48, s42, s48
    s_cmp_ge_u32 s41, 8
    s_cselect_b32 s52, s46, s44
    s_cselect_b32 s53, s47, s45
    s_and_b32 s41, s41, 7
    s_mul_i32 s41, s41, 160
    s_lshl_b32 s48, s48, 5
    s_add_u32 s41, s41, s48
    s_lshl_b32 s43, s43, 2

    s_mov_b32 s56, s52
    s_and_b32 s57, s53, 0xffff
    s_mov_b32 s58, 819200
    s_mov_b32 s59, 0x20000
    v_add_u32 v6, s43, v4
    v_mul_u32_u24 v7, 205, v6
    v_lshrrev_b32 v7, 10, v7
    v_mul_u32_u24 v8, 5, v7
    v_sub_u32 v8, v6, v8
    v_mul_u32_u24 v7, 40, v7
    v_lshrrev_b32 v9, 1, v8
    v_mul_u32_u24 v9, 20, v9
    v_and_b32 v11, 1, v8
    v_lshl_add_u32 v9, v11, 2, v9
    v_cmp_eq_u32 vcc, 4, v8
    v_mov_b32 v11, 8
    v_cndmask_b32 v9, v9, 16, vcc
    v_cndmask_b32 v11, v11, 20, vcc
    v_add_u32 v7, v7, v9
    v_add_u32 v11, v7, v11
    v_mul_u32_u24 v7, 1280, v7
    v_mul_u32_u24 v11, 1280, v11
    v_lshl_add_u32 v7, v5, 1, v7
    v_lshl_add_u32 v11, v5, 1, v11

    buffer_load_ushort v16, v7, s[56:59], s41 offen offset:0
    buffer_load_ushort v17, v7, s[56:59], s41 offen offset:1280
    buffer_load_ushort v18, v7, s[56:59], s41 offen offset:2560
    buffer_load_ushort v19, v7, s[56:59], s41 offen offset:3840
    buffer_load_ushort v20, v11, s[56:59], s41 offen offset:0
    buffer_load_ushort v21, v11, s[56:59], s41 offen offset:1280
    buffer_load_ushort v22, v11, s[56:59], s41 offen offset:2560
    buffer_load_ushort v23, v11, s[56:59], s41 offen offset:3840
    s_waitcnt vmcnt(12)
    s_barrier
    s_add_u32 m0, s67, 20480
    s_add_u32 s62, s65, 2293760
    buffer_load_dwordx4 v10, s[28:31], s62 offen lds
    s_add_u32 m0, s69, 24576
    s_add_u32 s62, s66, 2293760
    buffer_load_dword v2, s[28:31], s62 offen lds
    s_add_u32 m0, s67, 25600
    s_add_u32 s62, s68, 71680
    buffer_load_dwordx4 v10, s[32:35], s62 offen lds
    s_add_u32 m0, s69, 29696
    s_add_u32 s62, s70, 75776
    s_mov_b64 exec, s[60:61]
    buffer_load_dwordx4 v10, s[32:35], s62 offen lds
    s_mov_b64 exec, -1
    s_add_u32 s51, s50, 1024
    s_min_u32 s40, s51, 1599
    s_mul_i32 s41, s40, 5243
    s_lshr_b32 s41, s41, 19
    s_mul_i32 s42, s41, 100
    s_sub_u32 s42, s40, s42
    s_mul_i32 s43, s42, 205
    s_lshr_b32 s43, s43, 10
    s_mul_i32 s48, s43, 5
    s_sub_u32 s48, s42, s48
    s_cmp_ge_u32 s41, 8
    s_cselect_b32 s52, s46, s44
    s_cselect_b32 s53, s47, s45
    s_and_b32 s41, s41, 7
    s_mul_i32 s41, s41, 160
    s_lshl_b32 s48, s48, 5
    s_add_u32 s41, s41, s48
    s_lshl_b32 s43, s43, 2

    s_mov_b32 s56, s52
    s_and_b32 s57, s53, 0xffff
    s_mov_b32 s58, 819200
    s_mov_b32 s59, 0x20000
    v_add_u32 v6, s43, v4
    v_mul_u32_u24 v7, 205, v6
    v_lshrrev_b32 v7, 10, v7
    v_mul_u32_u24 v8, 5, v7
    v_sub_u32 v8, v6, v8
    v_mul_u32_u24 v7, 40, v7
    v_lshrrev_b32 v9, 1, v8
    v_mul_u32_u24 v9, 20, v9
    v_and_b32 v11, 1, v8
    v_lshl_add_u32 v9, v11, 2, v9
    v_cmp_eq_u32 vcc, 4, v8
    v_mov_b32 v11, 8
    v_cndmask_b32 v9, v9, 16, vcc
    v_cndmask_b32 v11, v11, 20, vcc
    v_add_u32 v7, v7, v9
    v_add_u32 v11, v7, v11
    v_mul_u32_u24 v7, 1280, v7
    v_mul_u32_u24 v11, 1280, v11
    v_lshl_add_u32 v7, v5, 1, v7
    v_lshl_add_u32 v11, v5, 1, v11

    buffer_load_ushort v32, v7, s[56:59], s41 offen offset:0
    buffer_load_ushort v33, v7, s[56:59], s41 offen offset:1280
    buffer_load_ushort v34, v7, s[56:59], s41 offen offset:2560
    buffer_load_ushort v35, v7, s[56:59], s41 offen offset:3840
    buffer_load_ushort v36, v11, s[56:59], s41 offen offset:0
    buffer_load_ushort v37, v11, s[56:59], s41 offen offset:1280
    buffer_load_ushort v38, v11, s[56:59], s41 offen offset:2560
    buffer_load_ushort v39, v11, s[56:59], s41 offen offset:3840
    s_waitcnt vmcnt(20)
    s_barrier
    s_add_u32 m0, s67, 30720
    s_add_u32 s62, s65, 2457600
    buffer_load_dwordx4 v10, s[28:31], s62 offen lds
    s_add_u32 m0, s69, 34816
    s_add_u32 s62, s66, 2457600
    buffer_load_dword v2, s[28:31], s62 offen lds
    s_add_u32 m0, s67, 35840
    s_add_u32 s62, s68, 76800
    buffer_load_dwordx4 v10, s[32:35], s62 offen lds
    s_add_u32 m0, s69, 39936
    s_add_u32 s62, s70, 80896
    s_mov_b64 exec, s[60:61]
    buffer_load_dwordx4 v10, s[32:35], s62 offen lds
    s_mov_b64 exec, -1
    s_waitcnt vmcnt(12)
    s_barrier
    s_waitcnt vmcnt(0)
    s_barrier
    s_waitcnt vmcnt(0)
    v_lshl_or_b32 v24, v17, 16, v16
    v_lshl_or_b32 v25, v19, 16, v18
    v_lshl_or_b32 v26, v21, 16, v20
    v_lshl_or_b32 v27, v23, 16, v22
    s_lshl_b32 s48, s50, 10
    buffer_store_dwordx4 v[24:27], v10, s[36:39], s48 offen sc1
    s_cmp_lt_u32 s51, 1600
    s_cbranch_scc0 K2_WPDONE
    v_lshl_or_b32 v24, v33, 16, v32
    v_lshl_or_b32 v25, v35, 16, v34
    v_lshl_or_b32 v26, v37, 16, v36
    v_lshl_or_b32 v27, v39, 16, v38
    s_lshl_b32 s48, s51, 10
    buffer_store_dwordx4 v[24:27], v10, s[36:39], s48 offen sc1
K2_WPDONE:
    s_endpgm
K2_GEMM:
    s_sub_u32 s7, s7, 8
    v_mov_b32 v114, v1
    v_and_b32 v3, 31, v114
    v_lshrrev_b32 v4, 5, v114
    v_lshlrev_b32 v5, 7, v3
    v_add_u32 v5, 40960, v5
    v_bfe_u32 v6, v3, 1, 3

    v_add_u32 v7, 0, v4
    v_xor_b32 v7, v7, v6
    v_lshl_add_u32 v104, v7, 4, v5
    v_add_u32 v108, 73728, v104
    v_add_u32 v7, 2, v4
    v_xor_b32 v7, v7, v6
    v_lshl_add_u32 v105, v7, 4, v5
    v_add_u32 v109, 73728, v105
    v_add_u32 v7, 4, v4
    v_xor_b32 v7, v7, v6
    v_lshl_add_u32 v106, v7, 4, v5
    v_add_u32 v110, 73728, v106
    v_add_u32 v7, 6, v4
    v_xor_b32 v7, v7, v6
    v_lshl_add_u32 v107, v7, 4, v5
    v_add_u32 v111, 73728, v107
    v_and_b32 v5, 15, v114
    v_lshrrev_b32 v6, 2, v5
    v_lshlrev_b32 v7, 3, v4
    v_add_u32 v7, v7, v6
    v_lshlrev_b32 v7, 8, v7
    v_bfe_u32 v8, v114, 4, 1
    v_lshl_add_u32 v7, v8, 5, v7
    v_and_b32 v8, 3, v5
    v_lshl_add_u32 v7, v8, 3, v7
    v_add_u32 v7, 61440, v7
    v_xor_b32 v8, s7, v6
    v_lshl_add_u32 v112, v8, 6, v7
    v_add_u32 v113, 73728, v112

    v_mov_b32 v0, 0
    v_mov_b32 v1, 0
    v_mov_b32 v2, 0
    v_mov_b32 v3, 0
    v_mov_b32 v4, 0
    v_mov_b32 v5, 0
    v_mov_b32 v6, 0
    v_mov_b32 v7, 0
    v_mov_b32 v8, 0
    v_mov_b32 v9, 0
    v_mov_b32 v10, 0
    v_mov_b32 v11, 0
    v_mov_b32 v12, 0
    v_mov_b32 v13, 0
    v_mov_b32 v14, 0
    v_mov_b32 v15, 0
    v_mov_b32 v16, 0
    v_mov_b32 v17, 0
    v_mov_b32 v18, 0
    v_mov_b32 v19, 0
    v_mov_b32 v20, 0
    v_mov_b32 v21, 0
    v_mov_b32 v22, 0
    v_mov_b32 v23, 0
    v_mov_b32 v24, 0
    v_mov_b32 v25, 0
    v_mov_b32 v26, 0
    v_mov_b32 v27, 0
    v_mov_b32 v28, 0
    v_mov_b32 v29, 0
    v_mov_b32 v30, 0
    v_mov_b32 v31, 0
    v_mov_b32 v32, 0
    v_mov_b32 v33, 0
    v_mov_b32 v34, 0
    v_mov_b32 v35, 0
    v_mov_b32 v36, 0
    v_mov_b32 v37, 0
    v_mov_b32 v38, 0
    v_mov_b32 v39, 0
    v_mov_b32 v40, 0
    v_mov_b32 v41, 0
    v_mov_b32 v42, 0
    v_mov_b32 v43, 0
    v_mov_b32 v44, 0
    v_mov_b32 v45, 0
    v_mov_b32 v46, 0
    v_mov_b32 v47, 0
    v_mov_b32 v48, 0
    v_mov_b32 v49, 0
    v_mov_b32 v50, 0
    v_mov_b32 v51, 0
    v_mov_b32 v52, 0
    v_mov_b32 v53, 0
    v_mov_b32 v54, 0
    v_mov_b32 v55, 0
    v_mov_b32 v56, 0
    v_mov_b32 v57, 0
    v_mov_b32 v58, 0
    v_mov_b32 v59, 0
    v_mov_b32 v60, 0
    v_mov_b32 v61, 0
    v_mov_b32 v62, 0
    v_mov_b32 v63, 0
    v_mov_b32 v64, 0
    v_mov_b32 v65, 0
    v_mov_b32 v66, 0
    v_mov_b32 v67, 0
    v_mov_b32 v68, 0
    v_mov_b32 v69, 0
    v_mov_b32 v70, 0
    v_mov_b32 v71, 0
    v_mov_b32 v72, 0
    v_mov_b32 v73, 0
    v_mov_b32 v74, 0
    v_mov_b32 v75, 0
    v_mov_b32 v76, 0
    v_mov_b32 v77, 0
    v_mov_b32 v78, 0
    v_mov_b32 v79, 0
    s_barrier
    s_barrier
    s_barrier
    ds_read_b64_tr_b16 v[100:101], v112 offset:0
    ds_read_b64_tr_b16 v[102:103], v112 offset:1024
    ds_read_b128 v[80:83], v104 offset:0
    ds_read_b128 v[84:87], v104 offset:4096
    ds_read_b128 v[88:91], v104 offset:8192
    ds_read_b128 v[92:95], v104 offset:12288
    ds_read_b128 v[96:99], v104 offset:16384
    s_waitcnt lgkmcnt(4)
    v_mfma_f32_32x32x16_bf16 v[0:15], v[100:103], v[80:83], v[0:15]
    s_waitcnt lgkmcnt(3)
    v_mfma_f32_32x32x16_bf16 v[16:31], v[100:103], v[84:87], v[16:31]
    s_waitcnt lgkmcnt(2)
    v_mfma_f32_32x32x16_bf16 v[32:47], v[100:103], v[88:91], v[32:47]
    s_waitcnt lgkmcnt(1)
    v_mfma_f32_32x32x16_bf16 v[48:63], v[100:103], v[92:95], v[48:63]
    s_waitcnt lgkmcnt(0)
    v_mfma_f32_32x32x16_bf16 v[64:79], v[100:103], v[96:99], v[64:79]
    ds_read_b64_tr_b16 v[100:101], v112 offset:4096
    ds_read_b64_tr_b16 v[102:103], v112 offset:5120
    ds_read_b128 v[80:83], v105 offset:0
    ds_read_b128 v[84:87], v105 offset:4096
    ds_read_b128 v[88:91], v105 offset:8192
    ds_read_b128 v[92:95], v105 offset:12288
    ds_read_b128 v[96:99], v105 offset:16384
    s_waitcnt lgkmcnt(4)
    v_mfma_f32_32x32x16_bf16 v[0:15], v[100:103], v[80:83], v[0:15]
    s_waitcnt lgkmcnt(3)
    v_mfma_f32_32x32x16_bf16 v[16:31], v[100:103], v[84:87], v[16:31]
    s_waitcnt lgkmcnt(2)
    v_mfma_f32_32x32x16_bf16 v[32:47], v[100:103], v[88:91], v[32:47]
    s_waitcnt lgkmcnt(1)
    v_mfma_f32_32x32x16_bf16 v[48:63], v[100:103], v[92:95], v[48:63]
    s_waitcnt lgkmcnt(0)
    v_mfma_f32_32x32x16_bf16 v[64:79], v[100:103], v[96:99], v[64:79]
    ds_read_b64_tr_b16 v[100:101], v112 offset:8192
    ds_read_b64_tr_b16 v[102:103], v112 offset:9216
    ds_read_b128 v[80:83], v106 offset:0
    ds_read_b128 v[84:87], v106 offset:4096
    ds_read_b128 v[88:91], v106 offset:8192
    ds_read_b128 v[92:95], v106 offset:12288
    ds_read_b128 v[96:99], v106 offset:16384
    s_waitcnt lgkmcnt(4)
    v_mfma_f32_32x32x16_bf16 v[0:15], v[100:103], v[80:83], v[0:15]
    s_waitcnt lgkmcnt(3)
    v_mfma_f32_32x32x16_bf16 v[16:31], v[100:103], v[84:87], v[16:31]
    s_waitcnt lgkmcnt(2)
    v_mfma_f32_32x32x16_bf16 v[32:47], v[100:103], v[88:91], v[32:47]
    s_waitcnt lgkmcnt(1)
    v_mfma_f32_32x32x16_bf16 v[48:63], v[100:103], v[92:95], v[48:63]
    s_waitcnt lgkmcnt(0)
    v_mfma_f32_32x32x16_bf16 v[64:79], v[100:103], v[96:99], v[64:79]
    ds_read_b64_tr_b16 v[100:101], v112 offset:12288
    ds_read_b64_tr_b16 v[102:103], v112 offset:13312
    ds_read_b128 v[80:83], v107 offset:0
    ds_read_b128 v[84:87], v107 offset:4096
    ds_read_b128 v[88:91], v107 offset:8192
    ds_read_b128 v[92:95], v107 offset:12288
    ds_read_b128 v[96:99], v107 offset:16384
    s_waitcnt lgkmcnt(4)
    v_mfma_f32_32x32x16_bf16 v[0:15], v[100:103], v[80:83], v[0:15]
    s_waitcnt lgkmcnt(3)
    v_mfma_f32_32x32x16_bf16 v[16:31], v[100:103], v[84:87], v[16:31]
    s_waitcnt lgkmcnt(2)
    v_mfma_f32_32x32x16_bf16 v[32:47], v[100:103], v[88:91], v[32:47]
    s_waitcnt lgkmcnt(1)
    v_mfma_f32_32x32x16_bf16 v[48:63], v[100:103], v[92:95], v[48:63]
    s_waitcnt lgkmcnt(0)
    v_mfma_f32_32x32x16_bf16 v[64:79], v[100:103], v[96:99], v[64:79]
    s_barrier
    ds_read_b64_tr_b16 v[100:101], v112 offset:36864
    ds_read_b64_tr_b16 v[102:103], v112 offset:37888
    ds_read_b128 v[80:83], v104 offset:36864
    ds_read_b128 v[84:87], v104 offset:40960
    ds_read_b128 v[88:91], v104 offset:45056
    ds_read_b128 v[92:95], v104 offset:49152
    ds_read_b128 v[96:99], v104 offset:53248
    s_waitcnt lgkmcnt(4)
    v_mfma_f32_32x32x16_bf16 v[0:15], v[100:103], v[80:83], v[0:15]
    s_waitcnt lgkmcnt(3)
    v_mfma_f32_32x32x16_bf16 v[16:31], v[100:103], v[84:87], v[16:31]
    s_waitcnt lgkmcnt(2)
    v_mfma_f32_32x32x16_bf16 v[32:47], v[100:103], v[88:91], v[32:47]
    s_waitcnt lgkmcnt(1)
    v_mfma_f32_32x32x16_bf16 v[48:63], v[100:103], v[92:95], v[48:63]
    s_waitcnt lgkmcnt(0)
    v_mfma_f32_32x32x16_bf16 v[64:79], v[100:103], v[96:99], v[64:79]
    ds_read_b64_tr_b16 v[100:101], v112 offset:40960
    ds_read_b64_tr_b16 v[102:103], v112 offset:41984
    ds_read_b128 v[80:83], v105 offset:36864
    ds_read_b128 v[84:87], v105 offset:40960
    ds_read_b128 v[88:91], v105 offset:45056
    ds_read_b128 v[92:95], v105 offset:49152
    ds_read_b128 v[96:99], v105 offset:53248
    s_waitcnt lgkmcnt(4)
    v_mfma_f32_32x32x16_bf16 v[0:15], v[100:103], v[80:83], v[0:15]
    s_waitcnt lgkmcnt(3)
    v_mfma_f32_32x32x16_bf16 v[16:31], v[100:103], v[84:87], v[16:31]
    s_waitcnt lgkmcnt(2)
    v_mfma_f32_32x32x16_bf16 v[32:47], v[100:103], v[88:91], v[32:47]
    s_waitcnt lgkmcnt(1)
    v_mfma_f32_32x32x16_bf16 v[48:63], v[100:103], v[92:95], v[48:63]
    s_waitcnt lgkmcnt(0)
    v_mfma_f32_32x32x16_bf16 v[64:79], v[100:103], v[96:99], v[64:79]
    ds_read_b64_tr_b16 v[100:101], v112 offset:45056
    ds_read_b64_tr_b16 v[102:103], v112 offset:46080
    ds_read_b128 v[80:83], v106 offset:36864
    ds_read_b128 v[84:87], v106 offset:40960
    ds_read_b128 v[88:91], v106 offset:45056
    ds_read_b128 v[92:95], v106 offset:49152
    ds_read_b128 v[96:99], v106 offset:53248
    s_waitcnt lgkmcnt(4)
    v_mfma_f32_32x32x16_bf16 v[0:15], v[100:103], v[80:83], v[0:15]
    s_waitcnt lgkmcnt(3)
    v_mfma_f32_32x32x16_bf16 v[16:31], v[100:103], v[84:87], v[16:31]
    s_waitcnt lgkmcnt(2)
    v_mfma_f32_32x32x16_bf16 v[32:47], v[100:103], v[88:91], v[32:47]
    s_waitcnt lgkmcnt(1)
    v_mfma_f32_32x32x16_bf16 v[48:63], v[100:103], v[92:95], v[48:63]
    s_waitcnt lgkmcnt(0)
    v_mfma_f32_32x32x16_bf16 v[64:79], v[100:103], v[96:99], v[64:79]
    ds_read_b64_tr_b16 v[100:101], v112 offset:49152
    ds_read_b64_tr_b16 v[102:103], v112 offset:50176
    ds_read_b128 v[80:83], v107 offset:36864
    ds_read_b128 v[84:87], v107 offset:40960
    ds_read_b128 v[88:91], v107 offset:45056
    ds_read_b128 v[92:95], v107 offset:49152
    ds_read_b128 v[96:99], v107 offset:53248
    s_waitcnt lgkmcnt(4)
    v_mfma_f32_32x32x16_bf16 v[0:15], v[100:103], v[80:83], v[0:15]
    s_waitcnt lgkmcnt(3)
    v_mfma_f32_32x32x16_bf16 v[16:31], v[100:103], v[84:87], v[16:31]
    s_waitcnt lgkmcnt(2)
    v_mfma_f32_32x32x16_bf16 v[32:47], v[100:103], v[88:91], v[32:47]
    s_waitcnt lgkmcnt(1)
    v_mfma_f32_32x32x16_bf16 v[48:63], v[100:103], v[92:95], v[48:63]
    s_waitcnt lgkmcnt(0)
    v_mfma_f32_32x32x16_bf16 v[64:79], v[100:103], v[96:99], v[64:79]
    s_barrier
    ds_read_b64_tr_b16 v[100:101], v113 offset:0
    ds_read_b64_tr_b16 v[102:103], v113 offset:1024
    ds_read_b128 v[80:83], v108 offset:0
    ds_read_b128 v[84:87], v108 offset:4096
    ds_read_b128 v[88:91], v108 offset:8192
    ds_read_b128 v[92:95], v108 offset:12288
    ds_read_b128 v[96:99], v108 offset:16384
    s_waitcnt lgkmcnt(4)
    v_mfma_f32_32x32x16_bf16 v[0:15], v[100:103], v[80:83], v[0:15]
    s_waitcnt lgkmcnt(3)
    v_mfma_f32_32x32x16_bf16 v[16:31], v[100:103], v[84:87], v[16:31]
    s_waitcnt lgkmcnt(2)
    v_mfma_f32_32x32x16_bf16 v[32:47], v[100:103], v[88:91], v[32:47]
    s_waitcnt lgkmcnt(1)
    v_mfma_f32_32x32x16_bf16 v[48:63], v[100:103], v[92:95], v[48:63]
    s_waitcnt lgkmcnt(0)
    v_mfma_f32_32x32x16_bf16 v[64:79], v[100:103], v[96:99], v[64:79]
    ds_read_b64_tr_b16 v[100:101], v113 offset:4096
    ds_read_b64_tr_b16 v[102:103], v113 offset:5120
    ds_read_b128 v[80:83], v109 offset:0
    ds_read_b128 v[84:87], v109 offset:4096
    ds_read_b128 v[88:91], v109 offset:8192
    ds_read_b128 v[92:95], v109 offset:12288
    ds_read_b128 v[96:99], v109 offset:16384
    s_waitcnt lgkmcnt(4)
    v_mfma_f32_32x32x16_bf16 v[0:15], v[100:103], v[80:83], v[0:15]
    s_waitcnt lgkmcnt(3)
    v_mfma_f32_32x32x16_bf16 v[16:31], v[100:103], v[84:87], v[16:31]
    s_waitcnt lgkmcnt(2)
    v_mfma_f32_32x32x16_bf16 v[32:47], v[100:103], v[88:91], v[32:47]
    s_waitcnt lgkmcnt(1)
    v_mfma_f32_32x32x16_bf16 v[48:63], v[100:103], v[92:95], v[48:63]
    s_waitcnt lgkmcnt(0)
    v_mfma_f32_32x32x16_bf16 v[64:79], v[100:103], v[96:99], v[64:79]
    ds_read_b64_tr_b16 v[100:101], v113 offset:8192
    ds_read_b64_tr_b16 v[102:103], v113 offset:9216
    ds_read_b128 v[80:83], v110 offset:0
    ds_read_b128 v[84:87], v110 offset:4096
    ds_read_b128 v[88:91], v110 offset:8192
    ds_read_b128 v[92:95], v110 offset:12288
    ds_read_b128 v[96:99], v110 offset:16384
    s_waitcnt lgkmcnt(4)
    v_mfma_f32_32x32x16_bf16 v[0:15], v[100:103], v[80:83], v[0:15]
    s_waitcnt lgkmcnt(3)
    v_mfma_f32_32x32x16_bf16 v[16:31], v[100:103], v[84:87], v[16:31]
    s_waitcnt lgkmcnt(2)
    v_mfma_f32_32x32x16_bf16 v[32:47], v[100:103], v[88:91], v[32:47]
    s_waitcnt lgkmcnt(1)
    v_mfma_f32_32x32x16_bf16 v[48:63], v[100:103], v[92:95], v[48:63]
    s_waitcnt lgkmcnt(0)
    v_mfma_f32_32x32x16_bf16 v[64:79], v[100:103], v[96:99], v[64:79]
    ds_read_b64_tr_b16 v[100:101], v113 offset:12288
    ds_read_b64_tr_b16 v[102:103], v113 offset:13312
    ds_read_b128 v[80:83], v111 offset:0
    ds_read_b128 v[84:87], v111 offset:4096
    ds_read_b128 v[88:91], v111 offset:8192
    ds_read_b128 v[92:95], v111 offset:12288
    ds_read_b128 v[96:99], v111 offset:16384
    s_waitcnt lgkmcnt(4)
    v_mfma_f32_32x32x16_bf16 v[0:15], v[100:103], v[80:83], v[0:15]
    s_waitcnt lgkmcnt(3)
    v_mfma_f32_32x32x16_bf16 v[16:31], v[100:103], v[84:87], v[16:31]
    s_waitcnt lgkmcnt(2)
    v_mfma_f32_32x32x16_bf16 v[32:47], v[100:103], v[88:91], v[32:47]
    s_waitcnt lgkmcnt(1)
    v_mfma_f32_32x32x16_bf16 v[48:63], v[100:103], v[92:95], v[48:63]
    s_waitcnt lgkmcnt(0)
    v_mfma_f32_32x32x16_bf16 v[64:79], v[100:103], v[96:99], v[64:79]
    s_barrier
    ds_read_b64_tr_b16 v[100:101], v112 offset:0
    ds_read_b64_tr_b16 v[102:103], v112 offset:1024
    ds_read_b128 v[80:83], v104 offset:0
    ds_read_b128 v[84:87], v104 offset:4096
    ds_read_b128 v[88:91], v104 offset:8192
    ds_read_b128 v[92:95], v104 offset:12288
    ds_read_b128 v[96:99], v104 offset:16384
    s_waitcnt lgkmcnt(4)
    v_mfma_f32_32x32x16_bf16 v[0:15], v[100:103], v[80:83], v[0:15]
    s_waitcnt lgkmcnt(3)
    v_mfma_f32_32x32x16_bf16 v[16:31], v[100:103], v[84:87], v[16:31]
    s_waitcnt lgkmcnt(2)
    v_mfma_f32_32x32x16_bf16 v[32:47], v[100:103], v[88:91], v[32:47]
    s_waitcnt lgkmcnt(1)
    v_mfma_f32_32x32x16_bf16 v[48:63], v[100:103], v[92:95], v[48:63]
    s_waitcnt lgkmcnt(0)
    v_mfma_f32_32x32x16_bf16 v[64:79], v[100:103], v[96:99], v[64:79]
    ds_read_b64_tr_b16 v[100:101], v112 offset:4096
    ds_read_b64_tr_b16 v[102:103], v112 offset:5120
    ds_read_b128 v[80:83], v105 offset:0
    ds_read_b128 v[84:87], v105 offset:4096
    ds_read_b128 v[88:91], v105 offset:8192
    ds_read_b128 v[92:95], v105 offset:12288
    ds_read_b128 v[96:99], v105 offset:16384
    s_waitcnt lgkmcnt(4)
    v_mfma_f32_32x32x16_bf16 v[0:15], v[100:103], v[80:83], v[0:15]
    s_waitcnt lgkmcnt(3)
    v_mfma_f32_32x32x16_bf16 v[16:31], v[100:103], v[84:87], v[16:31]
    s_waitcnt lgkmcnt(2)
    v_mfma_f32_32x32x16_bf16 v[32:47], v[100:103], v[88:91], v[32:47]
    s_waitcnt lgkmcnt(1)
    v_mfma_f32_32x32x16_bf16 v[48:63], v[100:103], v[92:95], v[48:63]
    s_waitcnt lgkmcnt(0)
    v_mfma_f32_32x32x16_bf16 v[64:79], v[100:103], v[96:99], v[64:79]
    ds_read_b64_tr_b16 v[100:101], v112 offset:8192
    ds_read_b64_tr_b16 v[102:103], v112 offset:9216
    ds_read_b128 v[80:83], v106 offset:0
    ds_read_b128 v[84:87], v106 offset:4096
    ds_read_b128 v[88:91], v106 offset:8192
    ds_read_b128 v[92:95], v106 offset:12288
    ds_read_b128 v[96:99], v106 offset:16384
    s_waitcnt lgkmcnt(4)
    v_mfma_f32_32x32x16_bf16 v[0:15], v[100:103], v[80:83], v[0:15]
    s_waitcnt lgkmcnt(3)
    v_mfma_f32_32x32x16_bf16 v[16:31], v[100:103], v[84:87], v[16:31]
    s_waitcnt lgkmcnt(2)
    v_mfma_f32_32x32x16_bf16 v[32:47], v[100:103], v[88:91], v[32:47]
    s_waitcnt lgkmcnt(1)
    v_mfma_f32_32x32x16_bf16 v[48:63], v[100:103], v[92:95], v[48:63]
    s_waitcnt lgkmcnt(0)
    v_mfma_f32_32x32x16_bf16 v[64:79], v[100:103], v[96:99], v[64:79]
    ds_read_b64_tr_b16 v[100:101], v112 offset:12288
    ds_read_b64_tr_b16 v[102:103], v112 offset:13312
    ds_read_b128 v[80:83], v107 offset:0
    ds_read_b128 v[84:87], v107 offset:4096
    ds_read_b128 v[88:91], v107 offset:8192
    ds_read_b128 v[92:95], v107 offset:12288
    ds_read_b128 v[96:99], v107 offset:16384
    s_waitcnt lgkmcnt(4)
    v_mfma_f32_32x32x16_bf16 v[0:15], v[100:103], v[80:83], v[0:15]
    s_waitcnt lgkmcnt(3)
    v_mfma_f32_32x32x16_bf16 v[16:31], v[100:103], v[84:87], v[16:31]
    s_waitcnt lgkmcnt(2)
    v_mfma_f32_32x32x16_bf16 v[32:47], v[100:103], v[88:91], v[32:47]
    s_waitcnt lgkmcnt(1)
    v_mfma_f32_32x32x16_bf16 v[48:63], v[100:103], v[92:95], v[48:63]
    s_waitcnt lgkmcnt(0)
    v_mfma_f32_32x32x16_bf16 v[64:79], v[100:103], v[96:99], v[64:79]
    s_barrier
    ds_read_b64_tr_b16 v[100:101], v112 offset:36864
    ds_read_b64_tr_b16 v[102:103], v112 offset:37888
    ds_read_b128 v[80:83], v104 offset:36864
    ds_read_b128 v[84:87], v104 offset:40960
    ds_read_b128 v[88:91], v104 offset:45056
    ds_read_b128 v[92:95], v104 offset:49152
    ds_read_b128 v[96:99], v104 offset:53248
    s_waitcnt lgkmcnt(4)
    v_mfma_f32_32x32x16_bf16 v[0:15], v[100:103], v[80:83], v[0:15]
    s_waitcnt lgkmcnt(3)
    v_mfma_f32_32x32x16_bf16 v[16:31], v[100:103], v[84:87], v[16:31]
    s_waitcnt lgkmcnt(2)
    v_mfma_f32_32x32x16_bf16 v[32:47], v[100:103], v[88:91], v[32:47]
    s_waitcnt lgkmcnt(1)
    v_mfma_f32_32x32x16_bf16 v[48:63], v[100:103], v[92:95], v[48:63]
    s_waitcnt lgkmcnt(0)
    v_mfma_f32_32x32x16_bf16 v[64:79], v[100:103], v[96:99], v[64:79]
    ds_read_b64_tr_b16 v[100:101], v112 offset:40960
    ds_read_b64_tr_b16 v[102:103], v112 offset:41984
    ds_read_b128 v[80:83], v105 offset:36864
    ds_read_b128 v[84:87], v105 offset:40960
    ds_read_b128 v[88:91], v105 offset:45056
    ds_read_b128 v[92:95], v105 offset:49152
    ds_read_b128 v[96:99], v105 offset:53248
    s_waitcnt lgkmcnt(4)
    v_mfma_f32_32x32x16_bf16 v[0:15], v[100:103], v[80:83], v[0:15]
    s_waitcnt lgkmcnt(3)
    v_mfma_f32_32x32x16_bf16 v[16:31], v[100:103], v[84:87], v[16:31]
    s_waitcnt lgkmcnt(2)
    v_mfma_f32_32x32x16_bf16 v[32:47], v[100:103], v[88:91], v[32:47]
    s_waitcnt lgkmcnt(1)
    v_mfma_f32_32x32x16_bf16 v[48:63], v[100:103], v[92:95], v[48:63]
    s_waitcnt lgkmcnt(0)
    v_mfma_f32_32x32x16_bf16 v[64:79], v[100:103], v[96:99], v[64:79]
    ds_read_b64_tr_b16 v[100:101], v112 offset:45056
    ds_read_b64_tr_b16 v[102:103], v112 offset:46080
    ds_read_b128 v[80:83], v106 offset:36864
    ds_read_b128 v[84:87], v106 offset:40960
    ds_read_b128 v[88:91], v106 offset:45056
    ds_read_b128 v[92:95], v106 offset:49152
    ds_read_b128 v[96:99], v106 offset:53248
    s_waitcnt lgkmcnt(4)
    v_mfma_f32_32x32x16_bf16 v[0:15], v[100:103], v[80:83], v[0:15]
    s_waitcnt lgkmcnt(3)
    v_mfma_f32_32x32x16_bf16 v[16:31], v[100:103], v[84:87], v[16:31]
    s_waitcnt lgkmcnt(2)
    v_mfma_f32_32x32x16_bf16 v[32:47], v[100:103], v[88:91], v[32:47]
    s_waitcnt lgkmcnt(1)
    v_mfma_f32_32x32x16_bf16 v[48:63], v[100:103], v[92:95], v[48:63]
    s_waitcnt lgkmcnt(0)
    v_mfma_f32_32x32x16_bf16 v[64:79], v[100:103], v[96:99], v[64:79]
    ds_read_b64_tr_b16 v[100:101], v112 offset:49152
    ds_read_b64_tr_b16 v[102:103], v112 offset:50176
    ds_read_b128 v[80:83], v107 offset:36864
    ds_read_b128 v[84:87], v107 offset:40960
    ds_read_b128 v[88:91], v107 offset:45056
    ds_read_b128 v[92:95], v107 offset:49152
    ds_read_b128 v[96:99], v107 offset:53248
    s_waitcnt lgkmcnt(4)
    v_mfma_f32_32x32x16_bf16 v[0:15], v[100:103], v[80:83], v[0:15]
    s_waitcnt lgkmcnt(3)
    v_mfma_f32_32x32x16_bf16 v[16:31], v[100:103], v[84:87], v[16:31]
    s_waitcnt lgkmcnt(2)
    v_mfma_f32_32x32x16_bf16 v[32:47], v[100:103], v[88:91], v[32:47]
    s_waitcnt lgkmcnt(1)
    v_mfma_f32_32x32x16_bf16 v[48:63], v[100:103], v[92:95], v[48:63]
    s_waitcnt lgkmcnt(0)
    v_mfma_f32_32x32x16_bf16 v[64:79], v[100:103], v[96:99], v[64:79]
    s_barrier
    ds_read_b64_tr_b16 v[100:101], v113 offset:0
    ds_read_b64_tr_b16 v[102:103], v113 offset:1024
    ds_read_b128 v[80:83], v108 offset:0
    ds_read_b128 v[84:87], v108 offset:4096
    ds_read_b128 v[88:91], v108 offset:8192
    ds_read_b128 v[92:95], v108 offset:12288
    ds_read_b128 v[96:99], v108 offset:16384
    s_waitcnt lgkmcnt(4)
    v_mfma_f32_32x32x16_bf16 v[0:15], v[100:103], v[80:83], v[0:15]
    s_waitcnt lgkmcnt(3)
    v_mfma_f32_32x32x16_bf16 v[16:31], v[100:103], v[84:87], v[16:31]
    s_waitcnt lgkmcnt(2)
    v_mfma_f32_32x32x16_bf16 v[32:47], v[100:103], v[88:91], v[32:47]
    s_waitcnt lgkmcnt(1)
    v_mfma_f32_32x32x16_bf16 v[48:63], v[100:103], v[92:95], v[48:63]
    s_waitcnt lgkmcnt(0)
    v_mfma_f32_32x32x16_bf16 v[64:79], v[100:103], v[96:99], v[64:79]
    ds_read_b64_tr_b16 v[100:101], v113 offset:4096
    ds_read_b64_tr_b16 v[102:103], v113 offset:5120
    ds_read_b128 v[80:83], v109 offset:0
    ds_read_b128 v[84:87], v109 offset:4096
    ds_read_b128 v[88:91], v109 offset:8192
    ds_read_b128 v[92:95], v109 offset:12288
    ds_read_b128 v[96:99], v109 offset:16384
    s_waitcnt lgkmcnt(4)
    v_mfma_f32_32x32x16_bf16 v[0:15], v[100:103], v[80:83], v[0:15]
    s_waitcnt lgkmcnt(3)
    v_mfma_f32_32x32x16_bf16 v[16:31], v[100:103], v[84:87], v[16:31]
    s_waitcnt lgkmcnt(2)
    v_mfma_f32_32x32x16_bf16 v[32:47], v[100:103], v[88:91], v[32:47]
    s_waitcnt lgkmcnt(1)
    v_mfma_f32_32x32x16_bf16 v[48:63], v[100:103], v[92:95], v[48:63]
    s_waitcnt lgkmcnt(0)
    v_mfma_f32_32x32x16_bf16 v[64:79], v[100:103], v[96:99], v[64:79]
    ds_read_b64_tr_b16 v[100:101], v113 offset:8192
    ds_read_b64_tr_b16 v[102:103], v113 offset:9216
    ds_read_b128 v[80:83], v110 offset:0
    ds_read_b128 v[84:87], v110 offset:4096
    ds_read_b128 v[88:91], v110 offset:8192
    ds_read_b128 v[92:95], v110 offset:12288
    ds_read_b128 v[96:99], v110 offset:16384
    s_waitcnt lgkmcnt(4)
    v_mfma_f32_32x32x16_bf16 v[0:15], v[100:103], v[80:83], v[0:15]
    s_waitcnt lgkmcnt(3)
    v_mfma_f32_32x32x16_bf16 v[16:31], v[100:103], v[84:87], v[16:31]
    s_waitcnt lgkmcnt(2)
    v_mfma_f32_32x32x16_bf16 v[32:47], v[100:103], v[88:91], v[32:47]
    s_waitcnt lgkmcnt(1)
    v_mfma_f32_32x32x16_bf16 v[48:63], v[100:103], v[92:95], v[48:63]
    s_waitcnt lgkmcnt(0)
    v_mfma_f32_32x32x16_bf16 v[64:79], v[100:103], v[96:99], v[64:79]
    ds_read_b64_tr_b16 v[100:101], v113 offset:12288
    ds_read_b64_tr_b16 v[102:103], v113 offset:13312
    ds_read_b128 v[80:83], v111 offset:0
    ds_read_b128 v[84:87], v111 offset:4096
    ds_read_b128 v[88:91], v111 offset:8192
    ds_read_b128 v[92:95], v111 offset:12288
    ds_read_b128 v[96:99], v111 offset:16384
    s_waitcnt lgkmcnt(4)
    v_mfma_f32_32x32x16_bf16 v[0:15], v[100:103], v[80:83], v[0:15]
    s_waitcnt lgkmcnt(3)
    v_mfma_f32_32x32x16_bf16 v[16:31], v[100:103], v[84:87], v[16:31]
    s_waitcnt lgkmcnt(2)
    v_mfma_f32_32x32x16_bf16 v[32:47], v[100:103], v[88:91], v[32:47]
    s_waitcnt lgkmcnt(1)
    v_mfma_f32_32x32x16_bf16 v[48:63], v[100:103], v[92:95], v[48:63]
    s_waitcnt lgkmcnt(0)
    v_mfma_f32_32x32x16_bf16 v[64:79], v[100:103], v[96:99], v[64:79]
    s_barrier
    ds_read_b64_tr_b16 v[100:101], v112 offset:0
    ds_read_b64_tr_b16 v[102:103], v112 offset:1024
    ds_read_b128 v[80:83], v104 offset:0
    ds_read_b128 v[84:87], v104 offset:4096
    ds_read_b128 v[88:91], v104 offset:8192
    ds_read_b128 v[92:95], v104 offset:12288
    ds_read_b128 v[96:99], v104 offset:16384
    s_waitcnt lgkmcnt(4)
    v_mfma_f32_32x32x16_bf16 v[0:15], v[100:103], v[80:83], v[0:15]
    s_waitcnt lgkmcnt(3)
    v_mfma_f32_32x32x16_bf16 v[16:31], v[100:103], v[84:87], v[16:31]
    s_waitcnt lgkmcnt(2)
    v_mfma_f32_32x32x16_bf16 v[32:47], v[100:103], v[88:91], v[32:47]
    s_waitcnt lgkmcnt(1)
    v_mfma_f32_32x32x16_bf16 v[48:63], v[100:103], v[92:95], v[48:63]
    s_waitcnt lgkmcnt(0)
    v_mfma_f32_32x32x16_bf16 v[64:79], v[100:103], v[96:99], v[64:79]
    ds_read_b64_tr_b16 v[100:101], v112 offset:4096
    ds_read_b64_tr_b16 v[102:103], v112 offset:5120
    ds_read_b128 v[80:83], v105 offset:0
    ds_read_b128 v[84:87], v105 offset:4096
    ds_read_b128 v[88:91], v105 offset:8192
    ds_read_b128 v[92:95], v105 offset:12288
    ds_read_b128 v[96:99], v105 offset:16384
    s_waitcnt lgkmcnt(4)
    v_mfma_f32_32x32x16_bf16 v[0:15], v[100:103], v[80:83], v[0:15]
    s_waitcnt lgkmcnt(3)
    v_mfma_f32_32x32x16_bf16 v[16:31], v[100:103], v[84:87], v[16:31]
    s_waitcnt lgkmcnt(2)
    v_mfma_f32_32x32x16_bf16 v[32:47], v[100:103], v[88:91], v[32:47]
    s_waitcnt lgkmcnt(1)
    v_mfma_f32_32x32x16_bf16 v[48:63], v[100:103], v[92:95], v[48:63]
    s_waitcnt lgkmcnt(0)
    v_mfma_f32_32x32x16_bf16 v[64:79], v[100:103], v[96:99], v[64:79]
    ds_read_b64_tr_b16 v[100:101], v112 offset:8192
    ds_read_b64_tr_b16 v[102:103], v112 offset:9216
    ds_read_b128 v[80:83], v106 offset:0
    ds_read_b128 v[84:87], v106 offset:4096
    ds_read_b128 v[88:91], v106 offset:8192
    ds_read_b128 v[92:95], v106 offset:12288
    ds_read_b128 v[96:99], v106 offset:16384
    s_waitcnt lgkmcnt(4)
    v_mfma_f32_32x32x16_bf16 v[0:15], v[100:103], v[80:83], v[0:15]
    s_waitcnt lgkmcnt(3)
    v_mfma_f32_32x32x16_bf16 v[16:31], v[100:103], v[84:87], v[16:31]
    s_waitcnt lgkmcnt(2)
    v_mfma_f32_32x32x16_bf16 v[32:47], v[100:103], v[88:91], v[32:47]
    s_waitcnt lgkmcnt(1)
    v_mfma_f32_32x32x16_bf16 v[48:63], v[100:103], v[92:95], v[48:63]
    s_waitcnt lgkmcnt(0)
    v_mfma_f32_32x32x16_bf16 v[64:79], v[100:103], v[96:99], v[64:79]
    ds_read_b64_tr_b16 v[100:101], v112 offset:12288
    ds_read_b64_tr_b16 v[102:103], v112 offset:13312
    ds_read_b128 v[80:83], v107 offset:0
    ds_read_b128 v[84:87], v107 offset:4096
    ds_read_b128 v[88:91], v107 offset:8192
    ds_read_b128 v[92:95], v107 offset:12288
    ds_read_b128 v[96:99], v107 offset:16384
    s_waitcnt lgkmcnt(4)
    v_mfma_f32_32x32x16_bf16 v[0:15], v[100:103], v[80:83], v[0:15]
    s_waitcnt lgkmcnt(3)
    v_mfma_f32_32x32x16_bf16 v[16:31], v[100:103], v[84:87], v[16:31]
    s_waitcnt lgkmcnt(2)
    v_mfma_f32_32x32x16_bf16 v[32:47], v[100:103], v[88:91], v[32:47]
    s_waitcnt lgkmcnt(1)
    v_mfma_f32_32x32x16_bf16 v[48:63], v[100:103], v[92:95], v[48:63]
    s_waitcnt lgkmcnt(0)
    v_mfma_f32_32x32x16_bf16 v[64:79], v[100:103], v[96:99], v[64:79]
    s_barrier
    ds_read_b64_tr_b16 v[100:101], v112 offset:36864
    ds_read_b64_tr_b16 v[102:103], v112 offset:37888
    ds_read_b128 v[80:83], v104 offset:36864
    ds_read_b128 v[84:87], v104 offset:40960
    ds_read_b128 v[88:91], v104 offset:45056
    ds_read_b128 v[92:95], v104 offset:49152
    ds_read_b128 v[96:99], v104 offset:53248
    s_waitcnt lgkmcnt(4)
    v_mfma_f32_32x32x16_bf16 v[0:15], v[100:103], v[80:83], v[0:15]
    s_waitcnt lgkmcnt(3)
    v_mfma_f32_32x32x16_bf16 v[16:31], v[100:103], v[84:87], v[16:31]
    s_waitcnt lgkmcnt(2)
    v_mfma_f32_32x32x16_bf16 v[32:47], v[100:103], v[88:91], v[32:47]
    s_waitcnt lgkmcnt(1)
    v_mfma_f32_32x32x16_bf16 v[48:63], v[100:103], v[92:95], v[48:63]
    s_waitcnt lgkmcnt(0)
    v_mfma_f32_32x32x16_bf16 v[64:79], v[100:103], v[96:99], v[64:79]
    ds_read_b64_tr_b16 v[100:101], v112 offset:40960
    ds_read_b64_tr_b16 v[102:103], v112 offset:41984
    ds_read_b128 v[80:83], v105 offset:36864
    ds_read_b128 v[84:87], v105 offset:40960
    ds_read_b128 v[88:91], v105 offset:45056
    ds_read_b128 v[92:95], v105 offset:49152
    ds_read_b128 v[96:99], v105 offset:53248
    s_waitcnt lgkmcnt(4)
    v_mfma_f32_32x32x16_bf16 v[0:15], v[100:103], v[80:83], v[0:15]
    s_waitcnt lgkmcnt(3)
    v_mfma_f32_32x32x16_bf16 v[16:31], v[100:103], v[84:87], v[16:31]
    s_waitcnt lgkmcnt(2)
    v_mfma_f32_32x32x16_bf16 v[32:47], v[100:103], v[88:91], v[32:47]
    s_waitcnt lgkmcnt(1)
    v_mfma_f32_32x32x16_bf16 v[48:63], v[100:103], v[92:95], v[48:63]
    s_waitcnt lgkmcnt(0)
    v_mfma_f32_32x32x16_bf16 v[64:79], v[100:103], v[96:99], v[64:79]
    ds_read_b64_tr_b16 v[100:101], v112 offset:45056
    ds_read_b64_tr_b16 v[102:103], v112 offset:46080
    ds_read_b128 v[80:83], v106 offset:36864
    ds_read_b128 v[84:87], v106 offset:40960
    ds_read_b128 v[88:91], v106 offset:45056
    ds_read_b128 v[92:95], v106 offset:49152
    ds_read_b128 v[96:99], v106 offset:53248
    s_waitcnt lgkmcnt(4)
    v_mfma_f32_32x32x16_bf16 v[0:15], v[100:103], v[80:83], v[0:15]
    s_waitcnt lgkmcnt(3)
    v_mfma_f32_32x32x16_bf16 v[16:31], v[100:103], v[84:87], v[16:31]
    s_waitcnt lgkmcnt(2)
    v_mfma_f32_32x32x16_bf16 v[32:47], v[100:103], v[88:91], v[32:47]
    s_waitcnt lgkmcnt(1)
    v_mfma_f32_32x32x16_bf16 v[48:63], v[100:103], v[92:95], v[48:63]
    s_waitcnt lgkmcnt(0)
    v_mfma_f32_32x32x16_bf16 v[64:79], v[100:103], v[96:99], v[64:79]
    ds_read_b64_tr_b16 v[100:101], v112 offset:49152
    ds_read_b64_tr_b16 v[102:103], v112 offset:50176
    ds_read_b128 v[80:83], v107 offset:36864
    ds_read_b128 v[84:87], v107 offset:40960
    ds_read_b128 v[88:91], v107 offset:45056
    ds_read_b128 v[92:95], v107 offset:49152
    ds_read_b128 v[96:99], v107 offset:53248
    s_waitcnt lgkmcnt(4)
    v_mfma_f32_32x32x16_bf16 v[0:15], v[100:103], v[80:83], v[0:15]
    s_waitcnt lgkmcnt(3)
    v_mfma_f32_32x32x16_bf16 v[16:31], v[100:103], v[84:87], v[16:31]
    s_waitcnt lgkmcnt(2)
    v_mfma_f32_32x32x16_bf16 v[32:47], v[100:103], v[88:91], v[32:47]
    s_waitcnt lgkmcnt(1)
    v_mfma_f32_32x32x16_bf16 v[48:63], v[100:103], v[92:95], v[48:63]
    s_waitcnt lgkmcnt(0)
    v_mfma_f32_32x32x16_bf16 v[64:79], v[100:103], v[96:99], v[64:79]
    s_barrier
    ds_read_b64_tr_b16 v[100:101], v113 offset:0
    ds_read_b64_tr_b16 v[102:103], v113 offset:1024
    ds_read_b128 v[80:83], v108 offset:0
    ds_read_b128 v[84:87], v108 offset:4096
    ds_read_b128 v[88:91], v108 offset:8192
    ds_read_b128 v[92:95], v108 offset:12288
    ds_read_b128 v[96:99], v108 offset:16384
    s_waitcnt lgkmcnt(4)
    v_mfma_f32_32x32x16_bf16 v[0:15], v[100:103], v[80:83], v[0:15]
    s_waitcnt lgkmcnt(3)
    v_mfma_f32_32x32x16_bf16 v[16:31], v[100:103], v[84:87], v[16:31]
    s_waitcnt lgkmcnt(2)
    v_mfma_f32_32x32x16_bf16 v[32:47], v[100:103], v[88:91], v[32:47]
    s_waitcnt lgkmcnt(1)
    v_mfma_f32_32x32x16_bf16 v[48:63], v[100:103], v[92:95], v[48:63]
    s_waitcnt lgkmcnt(0)
    v_mfma_f32_32x32x16_bf16 v[64:79], v[100:103], v[96:99], v[64:79]
    ds_read_b64_tr_b16 v[100:101], v113 offset:4096
    ds_read_b64_tr_b16 v[102:103], v113 offset:5120
    ds_read_b128 v[80:83], v109 offset:0
    ds_read_b128 v[84:87], v109 offset:4096
    ds_read_b128 v[88:91], v109 offset:8192
    ds_read_b128 v[92:95], v109 offset:12288
    ds_read_b128 v[96:99], v109 offset:16384
    s_waitcnt lgkmcnt(4)
    v_mfma_f32_32x32x16_bf16 v[0:15], v[100:103], v[80:83], v[0:15]
    s_waitcnt lgkmcnt(3)
    v_mfma_f32_32x32x16_bf16 v[16:31], v[100:103], v[84:87], v[16:31]
    s_waitcnt lgkmcnt(2)
    v_mfma_f32_32x32x16_bf16 v[32:47], v[100:103], v[88:91], v[32:47]
    s_waitcnt lgkmcnt(1)
    v_mfma_f32_32x32x16_bf16 v[48:63], v[100:103], v[92:95], v[48:63]
    s_waitcnt lgkmcnt(0)
    v_mfma_f32_32x32x16_bf16 v[64:79], v[100:103], v[96:99], v[64:79]
    ds_read_b64_tr_b16 v[100:101], v113 offset:8192
    ds_read_b64_tr_b16 v[102:103], v113 offset:9216
    ds_read_b128 v[80:83], v110 offset:0
    ds_read_b128 v[84:87], v110 offset:4096
    ds_read_b128 v[88:91], v110 offset:8192
    ds_read_b128 v[92:95], v110 offset:12288
    ds_read_b128 v[96:99], v110 offset:16384
    s_waitcnt lgkmcnt(4)
    v_mfma_f32_32x32x16_bf16 v[0:15], v[100:103], v[80:83], v[0:15]
    s_waitcnt lgkmcnt(3)
    v_mfma_f32_32x32x16_bf16 v[16:31], v[100:103], v[84:87], v[16:31]
    s_waitcnt lgkmcnt(2)
    v_mfma_f32_32x32x16_bf16 v[32:47], v[100:103], v[88:91], v[32:47]
    s_waitcnt lgkmcnt(1)
    v_mfma_f32_32x32x16_bf16 v[48:63], v[100:103], v[92:95], v[48:63]
    s_waitcnt lgkmcnt(0)
    v_mfma_f32_32x32x16_bf16 v[64:79], v[100:103], v[96:99], v[64:79]
    ds_read_b64_tr_b16 v[100:101], v113 offset:12288
    ds_read_b64_tr_b16 v[102:103], v113 offset:13312
    ds_read_b128 v[80:83], v111 offset:0
    ds_read_b128 v[84:87], v111 offset:4096
    ds_read_b128 v[88:91], v111 offset:8192
    ds_read_b128 v[92:95], v111 offset:12288
    ds_read_b128 v[96:99], v111 offset:16384
    s_waitcnt lgkmcnt(4)
    v_mfma_f32_32x32x16_bf16 v[0:15], v[100:103], v[80:83], v[0:15]
    s_waitcnt lgkmcnt(3)
    v_mfma_f32_32x32x16_bf16 v[16:31], v[100:103], v[84:87], v[16:31]
    s_waitcnt lgkmcnt(2)
    v_mfma_f32_32x32x16_bf16 v[32:47], v[100:103], v[88:91], v[32:47]
    s_waitcnt lgkmcnt(1)
    v_mfma_f32_32x32x16_bf16 v[48:63], v[100:103], v[92:95], v[48:63]
    s_waitcnt lgkmcnt(0)
    v_mfma_f32_32x32x16_bf16 v[64:79], v[100:103], v[96:99], v[64:79]
    s_barrier
    ds_read_b64_tr_b16 v[100:101], v112 offset:0
    ds_read_b64_tr_b16 v[102:103], v112 offset:1024
    ds_read_b128 v[80:83], v104 offset:0
    ds_read_b128 v[84:87], v104 offset:4096
    ds_read_b128 v[88:91], v104 offset:8192
    ds_read_b128 v[92:95], v104 offset:12288
    ds_read_b128 v[96:99], v104 offset:16384
    s_waitcnt lgkmcnt(4)
    v_mfma_f32_32x32x16_bf16 v[0:15], v[100:103], v[80:83], v[0:15]
    s_waitcnt lgkmcnt(3)
    v_mfma_f32_32x32x16_bf16 v[16:31], v[100:103], v[84:87], v[16:31]
    s_waitcnt lgkmcnt(2)
    v_mfma_f32_32x32x16_bf16 v[32:47], v[100:103], v[88:91], v[32:47]
    s_waitcnt lgkmcnt(1)
    v_mfma_f32_32x32x16_bf16 v[48:63], v[100:103], v[92:95], v[48:63]
    s_waitcnt lgkmcnt(0)
    v_mfma_f32_32x32x16_bf16 v[64:79], v[100:103], v[96:99], v[64:79]
    ds_read_b64_tr_b16 v[100:101], v112 offset:4096
    ds_read_b64_tr_b16 v[102:103], v112 offset:5120
    ds_read_b128 v[80:83], v105 offset:0
    ds_read_b128 v[84:87], v105 offset:4096
    ds_read_b128 v[88:91], v105 offset:8192
    ds_read_b128 v[92:95], v105 offset:12288
    ds_read_b128 v[96:99], v105 offset:16384
    s_waitcnt lgkmcnt(4)
    v_mfma_f32_32x32x16_bf16 v[0:15], v[100:103], v[80:83], v[0:15]
    s_waitcnt lgkmcnt(3)
    v_mfma_f32_32x32x16_bf16 v[16:31], v[100:103], v[84:87], v[16:31]
    s_waitcnt lgkmcnt(2)
    v_mfma_f32_32x32x16_bf16 v[32:47], v[100:103], v[88:91], v[32:47]
    s_waitcnt lgkmcnt(1)
    v_mfma_f32_32x32x16_bf16 v[48:63], v[100:103], v[92:95], v[48:63]
    s_waitcnt lgkmcnt(0)
    v_mfma_f32_32x32x16_bf16 v[64:79], v[100:103], v[96:99], v[64:79]
    ds_read_b64_tr_b16 v[100:101], v112 offset:8192
    ds_read_b64_tr_b16 v[102:103], v112 offset:9216
    ds_read_b128 v[80:83], v106 offset:0
    ds_read_b128 v[84:87], v106 offset:4096
    ds_read_b128 v[88:91], v106 offset:8192
    ds_read_b128 v[92:95], v106 offset:12288
    ds_read_b128 v[96:99], v106 offset:16384
    s_waitcnt lgkmcnt(4)
    v_mfma_f32_32x32x16_bf16 v[0:15], v[100:103], v[80:83], v[0:15]
    s_waitcnt lgkmcnt(3)
    v_mfma_f32_32x32x16_bf16 v[16:31], v[100:103], v[84:87], v[16:31]
    s_waitcnt lgkmcnt(2)
    v_mfma_f32_32x32x16_bf16 v[32:47], v[100:103], v[88:91], v[32:47]
    s_waitcnt lgkmcnt(1)
    v_mfma_f32_32x32x16_bf16 v[48:63], v[100:103], v[92:95], v[48:63]
    s_waitcnt lgkmcnt(0)
    v_mfma_f32_32x32x16_bf16 v[64:79], v[100:103], v[96:99], v[64:79]
    ds_read_b64_tr_b16 v[100:101], v112 offset:12288
    ds_read_b64_tr_b16 v[102:103], v112 offset:13312
    ds_read_b128 v[80:83], v107 offset:0
    ds_read_b128 v[84:87], v107 offset:4096
    ds_read_b128 v[88:91], v107 offset:8192
    ds_read_b128 v[92:95], v107 offset:12288
    ds_read_b128 v[96:99], v107 offset:16384
    s_waitcnt lgkmcnt(4)
    v_mfma_f32_32x32x16_bf16 v[0:15], v[100:103], v[80:83], v[0:15]
    s_waitcnt lgkmcnt(3)
    v_mfma_f32_32x32x16_bf16 v[16:31], v[100:103], v[84:87], v[16:31]
    s_waitcnt lgkmcnt(2)
    v_mfma_f32_32x32x16_bf16 v[32:47], v[100:103], v[88:91], v[32:47]
    s_waitcnt lgkmcnt(1)
    v_mfma_f32_32x32x16_bf16 v[48:63], v[100:103], v[92:95], v[48:63]
    s_waitcnt lgkmcnt(0)
    v_mfma_f32_32x32x16_bf16 v[64:79], v[100:103], v[96:99], v[64:79]
    s_barrier
    s_mov_b32 s41, 1051011932
    s_xor_b32 s40, s41, 0x80000000
    v_and_b32 v104, 31, v114
    v_mul_u32_u24 v104, 264, v104
    v_lshrrev_b32 v105, 5, v114
    v_lshl_add_u32 v104, v105, 3, v104
    s_lshl_b32 s42, s7, 6
    s_add_u32 s42, s42, 40960
    v_add_u32 v104, s42, v104
    s_nop 7

    v_cvt_pk_bf16_f32 v80, v0, v1
    v_cvt_pk_bf16_f32 v81, v2, v3
    ds_write_b64 v104, v[80:81] offset:0
    v_cvt_pk_bf16_f32 v82, v4, v5
    v_cvt_pk_bf16_f32 v83, v6, v7
    ds_write_b64 v104, v[82:83] offset:16
    v_cvt_pk_bf16_f32 v84, v8, v9
    v_cvt_pk_bf16_f32 v85, v10, v11
    ds_write_b64 v104, v[84:85] offset:32
    v_cvt_pk_bf16_f32 v86, v12, v13
    v_cvt_pk_bf16_f32 v87, v14, v15
    ds_write_b64 v104, v[86:87] offset:48
    v_cvt_pk_bf16_f32 v88, v16, v17
    v_cvt_pk_bf16_f32 v89, v18, v19
    ds_write_b64 v104, v[88:89] offset:8448
    v_cvt_pk_bf16_f32 v90, v20, v21
    v_cvt_pk_bf16_f32 v91, v22, v23
    ds_write_b64 v104, v[90:91] offset:8464
    v_cvt_pk_bf16_f32 v92, v24, v25
    v_cvt_pk_bf16_f32 v93, v26, v27
    ds_write_b64 v104, v[92:93] offset:8480
    v_cvt_pk_bf16_f32 v94, v28, v29
    v_cvt_pk_bf16_f32 v95, v30, v31
    ds_write_b64 v104, v[94:95] offset:8496
    v_cvt_pk_bf16_f32 v80, v32, v33
    v_cvt_pk_bf16_f32 v81, v34, v35
    ds_write_b64 v104, v[80:81] offset:16896
    v_cvt_pk_bf16_f32 v82, v36, v37
    v_cvt_pk_bf16_f32 v83, v38, v39
    ds_write_b64 v104, v[82:83] offset:16912
    v_cvt_pk_bf16_f32 v84, v40, v41
    v_cvt_pk_bf16_f32 v85, v42, v43
    ds_write_b64 v104, v[84:85] offset:16928
    v_cvt_pk_bf16_f32 v86, v44, v45
    v_cvt_pk_bf16_f32 v87, v46, v47
    ds_write_b64 v104, v[86:87] offset:16944
    v_cvt_pk_bf16_f32 v88, v48, v49
    v_cvt_pk_bf16_f32 v89, v50, v51
    ds_write_b64 v104, v[88:89] offset:25344
    v_cvt_pk_bf16_f32 v90, v52, v53
    v_cvt_pk_bf16_f32 v91, v54, v55
    ds_write_b64 v104, v[90:91] offset:25360
    v_cvt_pk_bf16_f32 v92, v56, v57
    v_cvt_pk_bf16_f32 v93, v58, v59
    ds_write_b64 v104, v[92:93] offset:25376
    v_cvt_pk_bf16_f32 v94, v60, v61
    v_cvt_pk_bf16_f32 v95, v62, v63
    ds_write_b64 v104, v[94:95] offset:25392
    v_cvt_pk_bf16_f32 v80, v64, v65
    v_cvt_pk_bf16_f32 v81, v66, v67
    ds_write_b64 v104, v[80:81] offset:33792
    v_cvt_pk_bf16_f32 v82, v68, v69
    v_cvt_pk_bf16_f32 v83, v70, v71
    ds_write_b64 v104, v[82:83] offset:33808
    v_cvt_pk_bf16_f32 v84, v72, v73
    v_cvt_pk_bf16_f32 v85, v74, v75
    ds_write_b64 v104, v[84:85] offset:33824
    v_cvt_pk_bf16_f32 v86, v76, v77
    v_cvt_pk_bf16_f32 v87, v78, v79
    ds_write_b64 v104, v[86:87] offset:33840
    s_waitcnt lgkmcnt(0)
    s_barrier
    s_add_u32 s22, s20, 18350080
    s_addc_u32 s23, s21, 0
    s_mov_b32 s52, s22
    s_and_b32 s53, s23, 0xffff
    s_mov_b32 s54, 2621440
    s_mov_b32 s55, 0x20000
    v_mov_b32 v1, v114
    s_lshl_b32 s8, s18, 2
    s_add_u32 s8, s8, s7
    s_mul_i32 s15, s8, 40960
    s_mul_i32 s11, s17, 5
    s_add_u32 s43, s7, 1
    s_mul_i32 s43, s43, 8448
    s_add_u32 s43, s43, 40960
    s_mov_b32 s74, 0
K2_BLOOP:
    s_mul_i32 s44, s74, 40
    s_add_u32 s44, s44, s43
    v_and_b32 v2, 31, v1
    v_lshrrev_b32 v3, 5, v1
    v_mul_u32_u24 v10, 264, v2
    v_lshl_add_u32 v11, v3, 4, v10
    v_add_u32 v11, s44, v11
    v_add_u32 v10, s44, v10
    v_subrev_u32 v13, 8448, v11
    v_subrev_u32 v14, 8448, v10
    ds_read_b64 v[72:73], v11
    ds_read_b64 v[74:75], v11 offset:8
    ds_read_b64 v[76:77], v10 offset:32
    ds_read_b64 v[96:97], v11 offset:80
    ds_read_b64 v[98:99], v11 offset:88
    ds_read_b64 v[100:101], v10 offset:112
    ds_read_b64 v[104:105], v13 offset:80
    ds_read_b64 v[106:107], v13 offset:88
    ds_read_b64 v[108:109], v14 offset:112
    v_and_b32 v4, 15, v1
    v_lshrrev_b32 v5, 2, v4
    v_lshl_add_u32 v5, v3, 2, v5
    v_mul_u32_u24 v12, 264, v5
    v_bfe_u32 v5, v1, 4, 1
    v_lshl_add_u32 v12, v5, 5, v12
    v_and_b32 v4, 3, v4
    v_lshl_add_u32 v12, v4, 3, v12
    v_add_u32 v12, s44, v12
    v_subrev_u32 v15, 4224, v12
    ds_read_b64_tr_b16 v[112:113], v12 offset:160
    ds_read_b64_tr_b16 v[114:115], v12 offset:2272
    ds_read_b64_tr_b16 v[116:117], v12 offset:4384
    ds_read_b64_tr_b16 v[118:119], v12 offset:6496
    ds_read_b64_tr_b16 v[120:121], v15 offset:160
    ds_read_b64_tr_b16 v[122:123], v15 offset:2272
    s_cmp_eq_u32 s8, 0
    s_cselect_b32 s17, 0, 1

    v_add_u32 v3, 18, v2
    v_mov_b32 v16, 0x5555
    v_mov_b32 v17, 0
    v_lshlrev_b64 v[16:17], v3, v[16:17]
    v_lshrrev_b32 v3, 5, v1
    v_lshlrev_b32 v3, 2, v3
    v_lshrrev_b64 v[16:17], v3, v[16:17]
    s_sub_u32 s62, 0, s17
    v_and_b32 v16, s62, v16
    v_not_b32 v16, v16
    v_not_b32 v17, v17

    v_bfe_i32 v32, v17, 0, 1
    v_lshlrev_b32 v32, 23, v32
    v_bfe_i32 v33, v17, 1, 1
    v_lshlrev_b32 v33, 23, v33
    v_bfe_i32 v34, v17, 2, 1
    v_lshlrev_b32 v34, 23, v34
    v_bfe_i32 v35, v17, 3, 1
    v_lshlrev_b32 v35, 23, v35
    v_bfe_i32 v36, v17, 8, 1
    v_lshlrev_b32 v36, 23, v36
    v_bfe_i32 v37, v17, 9, 1
    v_lshlrev_b32 v37, 23, v37
    v_bfe_i32 v38, v17, 10, 1
    v_lshlrev_b32 v38, 23, v38
    v_bfe_i32 v39, v17, 11, 1
    v_lshlrev_b32 v39, 23, v39
    v_bfe_i32 v40, v17, 16, 1
    v_lshlrev_b32 v40, 23, v40
    v_bfe_i32 v41, v17, 17, 1
    v_lshlrev_b32 v41, 23, v41
    v_bfe_i32 v42, v17, 18, 1
    v_lshlrev_b32 v42, 23, v42
    v_bfe_i32 v43, v17, 19, 1
    v_lshlrev_b32 v43, 23, v43
    v_bfe_i32 v44, v17, 24, 1
    v_lshlrev_b32 v44, 23, v44
    v_bfe_i32 v45, v17, 25, 1
    v_lshlrev_b32 v45, 23, v45
    v_bfe_i32 v46, v17, 26, 1
    v_lshlrev_b32 v46, 23, v46
    v_bfe_i32 v47, v17, 27, 1
    v_lshlrev_b32 v47, 23, v47
    v_bfe_i32 v56, v16, 16, 1
    v_lshlrev_b32 v56, 23, v56
    v_bfe_i32 v57, v16, 17, 1
    v_lshlrev_b32 v57, 23, v57
    v_bfe_i32 v58, v16, 18, 1
    v_lshlrev_b32 v58, 23, v58
    v_bfe_i32 v59, v16, 19, 1
    v_lshlrev_b32 v59, 23, v59
    v_bfe_i32 v60, v16, 24, 1
    v_lshlrev_b32 v60, 23, v60
    v_bfe_i32 v61, v16, 25, 1
    v_lshlrev_b32 v61, 23, v61
    v_bfe_i32 v62, v16, 26, 1
    v_lshlrev_b32 v62, 23, v62
    v_bfe_i32 v63, v16, 27, 1
    v_lshlrev_b32 v63, 23, v63
    v_cmp_gt_u32 vcc, 32, v1
    v_cmp_eq_u32 s[60:61], 20, v2
    v_mov_b32 v15, 0x3f803f80
    s_waitcnt lgkmcnt(0)
    v_cndmask_b32 v76, 0, v76, vcc
    v_cndmask_b32 v77, 0, v77, vcc

    v_cndmask_b32 v112, v112, v15, s[60:61]
    v_cndmask_b32 v113, v113, v15, s[60:61]
    v_cndmask_b32 v114, v114, v15, s[60:61]
    v_cndmask_b32 v115, v115, v15, s[60:61]
    v_cndmask_b32 v116, v116, v15, s[60:61]
    v_cndmask_b32 v117, v117, v15, s[60:61]
    v_cndmask_b32 v118, v118, v15, s[60:61]
    v_cndmask_b32 v119, v119, v15, s[60:61]
    v_cndmask_b32 v120, v120, v15, s[60:61]
    v_cndmask_b32 v121, v121, v15, s[60:61]
    v_cndmask_b32 v122, v122, v15, s[60:61]
    v_cndmask_b32 v123, v123, v15, s[60:61]
    s_nop 1
    v_mfma_f32_32x32x16_bf16 v[32:47], v[96:99], v[72:75], v[32:47]
    v_mfma_f32_32x32x16_bf16 v[48:63], v[104:107], v[72:75], v[48:63]
    v_mfma_f32_32x32x8_bf16 v[32:47], v[100:101], v[76:77], v[32:47]
    v_mfma_f32_32x32x8_bf16 v[48:63], v[108:109], v[76:77], v[48:63]
    s_nop 15
    v_max3_f32 v13, v32, v33, v34
    v_max3_f32 v13, v13, v35, v36
    v_max3_f32 v13, v13, v37, v38
    v_max3_f32 v13, v13, v39, v40
    v_max3_f32 v13, v13, v41, v42
    v_max3_f32 v13, v13, v43, v44
    v_max3_f32 v13, v13, v45, v46
    v_max3_f32 v13, v13, v47, v56
    v_max3_f32 v13, v13, v57, v58
    v_max3_f32 v13, v13, v59, v60
    v_max3_f32 v13, v13, v61, v62
    v_max_f32 v13, v13, v63
    v_mov_b32 v14, v13
    s_nop 1
    v_permlane32_swap_b32 v13, v14
    s_nop 1
    v_max_f32 v13, v13, v14
    s_cmp_eq_u32 s74, 0
    s_cbranch_scc0 K2_GNOMID
    s_barrier
K2_GNOMID:
    v_mul_f32 v14, s40, v13
    v_fma_f32 v32, v32, s41, v14
    v_fma_f32 v33, v33, s41, v14
    v_fma_f32 v34, v34, s41, v14
    v_fma_f32 v35, v35, s41, v14
    v_fma_f32 v36, v36, s41, v14
    v_fma_f32 v37, v37, s41, v14
    v_fma_f32 v38, v38, s41, v14
    v_fma_f32 v39, v39, s41, v14
    v_fma_f32 v40, v40, s41, v14
    v_fma_f32 v41, v41, s41, v14
    v_fma_f32 v42, v42, s41, v14
    v_fma_f32 v43, v43, s41, v14
    v_fma_f32 v44, v44, s41, v14
    v_fma_f32 v45, v45, s41, v14
    v_fma_f32 v46, v46, s41, v14
    v_fma_f32 v47, v47, s41, v14
    v_fma_f32 v56, v56, s41, v14
    v_fma_f32 v57, v57, s41, v14
    v_fma_f32 v58, v58, s41, v14
    v_fma_f32 v59, v59, s41, v14
    v_fma_f32 v60, v60, s41, v14
    v_fma_f32 v61, v61, s41, v14
    v_fma_f32 v62, v62, s41, v14
    v_fma_f32 v63, v63, s41, v14
    v_exp_f32 v32, v32
    v_exp_f32 v33, v33
    v_exp_f32 v34, v34
    v_exp_f32 v35, v35
    v_exp_f32 v36, v36
    v_exp_f32 v37, v37
    v_exp_f32 v38, v38
    v_exp_f32 v39, v39
    v_exp_f32 v40, v40
    v_exp_f32 v41, v41
    v_exp_f32 v42, v42
    v_exp_f32 v43, v43
    v_exp_f32 v44, v44
    v_exp_f32 v45, v45
    v_exp_f32 v46, v46
    v_exp_f32 v47, v47
    v_exp_f32 v56, v56
    v_exp_f32 v57, v57
    v_exp_f32 v58, v58
    v_exp_f32 v59, v59
    v_exp_f32 v60, v60
    v_exp_f32 v61, v61
    v_exp_f32 v62, v62
    v_exp_f32 v63, v63
    s_nop 0
    v_cvt_pk_bf16_f32 v64, v32, v33
    v_cvt_pk_bf16_f32 v65, v34, v35
    v_cvt_pk_bf16_f32 v66, v36, v37
    v_cvt_pk_bf16_f32 v67, v38, v39
    v_cvt_pk_bf16_f32 v68, v40, v41
    v_cvt_pk_bf16_f32 v69, v42, v43
    v_cvt_pk_bf16_f32 v70, v44, v45
    v_cvt_pk_bf16_f32 v71, v46, v47
    v_cvt_pk_bf16_f32 v72, v56, v57
    v_cvt_pk_bf16_f32 v73, v58, v59
    v_cvt_pk_bf16_f32 v74, v60, v61
    v_cvt_pk_bf16_f32 v75, v62, v63
    s_nop 1
    v_mfma_f32_32x32x16_bf16 v[80:95], v[112:115], v[64:67], 0
    v_mfma_f32_32x32x16_bf16 v[80:95], v[116:119], v[68:71], v[80:95]
    v_mfma_f32_32x32x16_bf16 v[80:95], v[120:123], v[72:75], v[80:95]
    s_lshl_b32 s62, s74, 1
    s_add_u32 s62, s62, s11
    s_lshl_b32 s62, s62, 9
    s_add_u32 s70, s62, s15
    s_add_u32 s62, s11, 4
    s_lshl_b32 s62, s62, 9
    s_lshl_b32 s63, s74, 3
    s_add_u32 s62, s62, s63
    s_add_u32 s71, s62, s15
    s_nop 15

    v_mov_b32 v13, v88
    v_mov_b32 v14, v88
    s_nop 1
    v_permlane32_swap_b32 v13, v14
    s_nop 1
    v_rcp_f32 v14, v14
    s_nop 1

    v_mul_f32 v80, v80, v14
    v_mul_f32 v81, v81, v14
    v_mul_f32 v82, v82, v14
    v_mul_f32 v83, v83, v14
    v_mul_f32 v84, v84, v14
    v_mul_f32 v85, v85, v14
    v_mul_f32 v86, v86, v14
    v_mul_f32 v87, v87, v14
    v_mul_f32 v88, v88, v14
    v_mul_f32 v89, v89, v14
    v_mul_f32 v90, v90, v14
    v_mul_f32 v91, v91, v14
    v_cvt_pk_bf16_f32 v64, v80, v81
    v_cvt_pk_bf16_f32 v65, v82, v83
    v_cvt_pk_bf16_f32 v66, v84, v85
    v_cvt_pk_bf16_f32 v67, v86, v87
    v_cvt_pk_bf16_f32 v68, v88, v89
    v_cvt_pk_bf16_f32 v69, v90, v91
    v_lshlrev_b32 v13, 4, v1
    buffer_store_dwordx4 v[64:67], v13, s[52:55], s70 offen sc1
    v_mov_b32 v15, 0x40000000
    v_cmp_gt_u32 vcc, 32, v1
    s_nop 1
    v_cndmask_b32 v15, v15, v13, vcc
    buffer_store_dwordx2 v[68:69], v15, s[52:55], s71 offen sc1

    s_add_u32 s74, s74, 1
    s_cmp_lt_u32 s74, 2
    s_cbranch_scc0 K2_GEND

    s_barrier

    s_branch K2_BLOOP
K2_GEND:

    s_endpgm
K2_COMPUTE:
    s_lshr_b32 s9, s5, 1
    s_and_b32 s10, s5, 1
    s_mul_i32 s11, s9, 5
    s_mul_i32 s12, s10, 3
    s_add_u32 s12, s12, s11
    s_lshl_b32 s12, s12, 9
    s_add_u32 s13, s11, 2
    s_lshl_b32 s13, s13, 9
    s_lshl_b32 s14, s10, 3
    s_add_u32 s13, s13, s14

    s_lshl_b32 s8, s6, 3
    s_add_u32 s8, s8, s7
    s_mul_i32 s15, s8, 40960
    v_and_b32 v2, 31, v1
    v_lshrrev_b32 v3, 5, v1
    v_lshlrev_b32 v13, 4, v2
    v_mov_b32 v14, 0x40000000
    v_cmp_gt_u32 vcc, 32, v1
    s_add_u32 s62, s15, s12
    s_add_u32 s63, s15, s13
    v_cndmask_b32 v14, v14, v13, vcc
    s_waitcnt lgkmcnt(0)

    s_add_u32 s22, s20, 0
    s_addc_u32 s23, s21, 0
    s_mov_b32 s24, s22
    s_and_b32 s25, s23, 0xffff
    s_mov_b32 s26, 2621440
    s_mov_b32 s27, 0x20000
    buffer_load_dwordx4 v[4:7], v10, s[24:27], s62 offen
    buffer_load_dwordx2 v[8:9], v14, s[24:27], s63 offen
    v_cmp_gt_u32 s[60:61], 20, v2
    v_cmp_eq_u32 vcc, 20, v2
    v_mov_b32 v15, 0x3f803f80
    v_lshlrev_b32 v11, 3, v2
    v_cndmask_b32 v15, 0, v15, vcc
    v_mul_u32_u24 v12, 320, v3
    v_add_u32 v12, v12, v13

    v_mov_b32 v112, v15
    v_mov_b32 v113, v15
    v_mov_b32 v114, v15
    v_mov_b32 v115, v15
    v_mov_b32 v116, v15
    v_mov_b32 v117, v15
    v_mov_b32 v118, v15
    v_mov_b32 v119, v15
    v_mov_b32 v120, v15
    v_mov_b32 v121, v15
    v_mov_b32 v122, v15
    v_mov_b32 v123, v15
    v_mov_b32 v124, v15
    v_mov_b32 v125, v15
    v_mov_b32 v126, v15
    v_mov_b32 v127, v15
    s_add_u32 s22, s20, 15728640
    s_addc_u32 s23, s21, 0
    s_mov_b32 s36, s22
    s_and_b32 s37, s23, 0xffff
    s_mov_b32 s38, 2621440
    s_mov_b32 s39, 0x20000
    s_lshl_b32 s56, s10, 1
    s_add_u32 s56, s56, s11
    s_lshl_b32 s56, s56, 9
    s_add_u32 s57, s11, 4
    s_lshl_b32 s57, s57, 9
    s_add_u32 s57, s57, s14
    s_add_u32 s70, s56, s15
    s_add_u32 s71, s57, s15

    s_setprio 1
    s_cmp_lt_u32 s7, 4
    s_cbranch_scc0 K2_NOPRIO
    s_setprio 2
K2_NOPRIO:
    s_waitcnt vmcnt(0)
    s_barrier
    ds_read_b128 v[96:99], v10
    ds_read_b64 v[100:101], v11 offset:4096
    ds_read_b128 v[104:107], v10 offset:1024
    ds_read_b64 v[108:109], v11 offset:4352
    s_mov_b64 exec, s[60:61]
    ds_read_b128 v[112:115], v12 offset:5120
    ds_read_b128 v[116:119], v12 offset:5760
    ds_read_b128 v[124:127], v12 offset:5760
    s_mov_b64 exec, -1
    s_waitcnt lgkmcnt(5)

    v_mfma_f32_32x32x16_bf16 v[32:47], v[96:99], v[4:7], 0
    v_mfma_f32_32x32x8_bf16 v[32:47], v[100:101], v[8:9], v[32:47]
    v_mov_b32 v80, 0
    v_mov_b32 v81, 0
    v_mov_b32 v82, 0
    v_mov_b32 v83, 0
    v_mov_b32 v84, 0
    v_mov_b32 v85, 0
    v_mov_b32 v86, 0
    v_mov_b32 v87, 0
    v_mov_b32 v88, 0
    v_mov_b32 v89, 0
    v_mov_b32 v90, 0
    v_mov_b32 v91, 0
    v_mov_b32 v92, 0
    v_mov_b32 v93, 0
    v_mov_b32 v94, 0
    v_mov_b32 v95, 0
    v_mov_b32 v68, 0
    v_mov_b32 v69, 0
    v_mov_b32 v70, 0
    v_mov_b32 v71, 0
    s_nop 3
    v_max3_f32 v13, v32, v33, v34
    v_max3_f32 v13, v13, v35, v36
    v_max3_f32 v13, v13, v37, v38
    v_max3_f32 v13, v13, v39, v40
    v_max3_f32 v13, v13, v41, v42
    v_max3_f32 v13, v13, v43, v44
    v_max3_f32 v13, v13, v45, v46
    v_max_f32 v13, v13, v47
    v_mov_b32 v14, v13
    s_nop 1
    v_permlane32_swap_b32 v13, v14
    s_nop 1
    v_max_f32 v13, v13, v14
    v_sub_f32 v16, 0, v13
    v_sub_f32 v17, 0, v13
    v_sub_f32 v18, 0, v13
    v_sub_f32 v19, 0, v13
    v_sub_f32 v20, 0, v13
    v_sub_f32 v21, 0, v13
    v_sub_f32 v22, 0, v13
    v_sub_f32 v23, 0, v13
    v_sub_f32 v24, 0, v13
    v_sub_f32 v25, 0, v13
    v_sub_f32 v26, 0, v13
    v_sub_f32 v27, 0, v13
    v_sub_f32 v28, 0, v13
    v_sub_f32 v29, 0, v13
    v_sub_f32 v30, 0, v13
    v_sub_f32 v31, 0, v13
    v_sub_f32 v32, v32, v13
    v_sub_f32 v33, v33, v13
    v_sub_f32 v34, v34, v13
    v_sub_f32 v35, v35, v13
    v_sub_f32 v36, v36, v13
    v_sub_f32 v37, v37, v13
    v_sub_f32 v38, v38, v13
    v_sub_f32 v39, v39, v13
    v_sub_f32 v40, v40, v13
    v_sub_f32 v41, v41, v13
    v_sub_f32 v42, v42, v13
    v_sub_f32 v43, v43, v13
    v_sub_f32 v44, v44, v13
    v_sub_f32 v45, v45, v13
    v_sub_f32 v46, v46, v13
    v_sub_f32 v47, v47, v13
    s_mov_b32 s74, 0
    s_mov_b32 s72, 0x07060302
K2_LOOP:
    s_cmp_eq_u32 s74, 0
    s_cbranch_scc1 K2_NOBAR0
    s_barrier
K2_NOBAR0:
    s_waitcnt lgkmcnt(0)
    v_mfma_f32_32x32x16_bf16 v[48:63], v[104:107], v[4:7], v[16:31]
    v_exp_f32 v32, v32
    v_exp_f32 v33, v33
    v_mfma_f32_32x32x16_bf16 v[80:95], v[124:127], v[68:71], v[80:95]
    s_mov_b64 exec, s[60:61]
    ds_read_b128 v[120:123], v12 offset:6400
    ds_read_b128 v[124:127], v12 offset:7040
    s_mov_b64 exec, -1
    v_exp_f32 v34, v34
    v_exp_f32 v35, v35
    v_perm_b32 v64, v33, v32, s72
    v_exp_f32 v36, v36
    v_perm_b32 v65, v35, v34, s72
    v_mfma_f32_32x32x8_bf16 v[48:63], v[108:109], v[8:9], v[48:63]
    ds_read_b128 v[96:99], v10 offset:2048
    ds_read_b64 v[100:101], v11 offset:4608
    v_exp_f32 v37, v37
    v_exp_f32 v38, v38
    v_exp_f32 v39, v39
    v_perm_b32 v66, v37, v36, s72
    v_exp_f32 v40, v40
    v_perm_b32 v67, v39, v38, s72
    v_exp_f32 v41, v41
    v_exp_f32 v42, v42
    v_mfma_f32_32x32x16_bf16 v[80:95], v[112:115], v[64:67], v[80:95]
    v_exp_f32 v43, v43
    v_perm_b32 v68, v41, v40, s72
    v_exp_f32 v44, v44
    v_exp_f32 v45, v45
    v_exp_f32 v46, v46
    v_exp_f32 v47, v47
    v_perm_b32 v69, v43, v42, s72
    v_perm_b32 v70, v45, v44, s72
    v_perm_b32 v71, v47, v46, s72
    s_waitcnt lgkmcnt(0)
    v_mfma_f32_32x32x16_bf16 v[32:47], v[96:99], v[4:7], v[16:31]
    v_exp_f32 v48, v48
    v_exp_f32 v49, v49
    v_mfma_f32_32x32x16_bf16 v[80:95], v[116:119], v[68:71], v[80:95]
    s_mov_b64 exec, s[60:61]
    ds_read_b128 v[112:115], v12 offset:7680
    ds_read_b128 v[116:119], v12 offset:8320
    s_mov_b64 exec, -1
    v_exp_f32 v50, v50
    v_exp_f32 v51, v51
    v_perm_b32 v64, v49, v48, s72
    v_exp_f32 v52, v52
    v_perm_b32 v65, v51, v50, s72
    v_mfma_f32_32x32x8_bf16 v[32:47], v[100:101], v[8:9], v[32:47]
    ds_read_b128 v[104:107], v10 offset:3072
    ds_read_b64 v[108:109], v11 offset:4864
    v_exp_f32 v53, v53
    v_exp_f32 v54, v54
    v_exp_f32 v55, v55
    v_perm_b32 v66, v53, v52, s72
    v_exp_f32 v56, v56
    v_perm_b32 v67, v55, v54, s72
    v_exp_f32 v57, v57
    v_exp_f32 v58, v58
    v_mfma_f32_32x32x16_bf16 v[80:95], v[120:123], v[64:67], v[80:95]
    v_exp_f32 v59, v59
    v_perm_b32 v68, v57, v56, s72
    v_exp_f32 v60, v60
    v_exp_f32 v61, v61
    v_exp_f32 v62, v62
    v_exp_f32 v63, v63
    v_perm_b32 v69, v59, v58, s72
    v_perm_b32 v70, v61, v60, s72
    v_perm_b32 v71, v63, v62, s72
    s_cmp_eq_u32 s74, 0
    s_cbranch_scc0 K2_NOBAR2
    s_barrier
K2_NOBAR2:
    s_waitcnt lgkmcnt(0)
    v_mfma_f32_32x32x16_bf16 v[48:63], v[104:107], v[4:7], v[16:31]
    v_exp_f32 v32, v32
    v_exp_f32 v33, v33
    v_mfma_f32_32x32x16_bf16 v[80:95], v[124:127], v[68:71], v[80:95]
    s_mov_b64 exec, s[60:61]
    ds_read_b128 v[120:123], v12 offset:8960
    ds_read_b128 v[124:127], v12 offset:9600
    s_mov_b64 exec, -1
    v_exp_f32 v34, v34
    v_exp_f32 v35, v35
    v_perm_b32 v64, v33, v32, s72
    v_exp_f32 v36, v36
    v_perm_b32 v65, v35, v34, s72
    v_mfma_f32_32x32x8_bf16 v[48:63], v[108:109], v[8:9], v[48:63]
    ds_read_b128 v[96:99], v10 offset:10240
    ds_read_b64 v[100:101], v11 offset:14336
    v_exp_f32 v37, v37
    v_exp_f32 v38, v38
    v_exp_f32 v39, v39
    v_perm_b32 v66, v37, v36, s72
    v_exp_f32 v40, v40
    v_perm_b32 v67, v39, v38, s72
    v_exp_f32 v41, v41
    v_exp_f32 v42, v42
    v_mfma_f32_32x32x16_bf16 v[80:95], v[112:115], v[64:67], v[80:95]
    v_exp_f32 v43, v43
    v_perm_b32 v68, v41, v40, s72
    v_exp_f32 v44, v44
    v_exp_f32 v45, v45
    v_exp_f32 v46, v46
    v_exp_f32 v47, v47
    v_perm_b32 v69, v43, v42, s72
    v_perm_b32 v70, v45, v44, s72
    v_perm_b32 v71, v47, v46, s72
    s_waitcnt lgkmcnt(0)
    v_mfma_f32_32x32x16_bf16 v[32:47], v[96:99], v[4:7], v[16:31]
    v_exp_f32 v48, v48
    v_exp_f32 v49, v49
    v_mfma_f32_32x32x16_bf16 v[80:95], v[116:119], v[68:71], v[80:95]
    s_mov_b64 exec, s[60:61]
    ds_read_b128 v[112:115], v12 offset:15360
    ds_read_b128 v[116:119], v12 offset:16000
    s_mov_b64 exec, -1
    v_exp_f32 v50, v50
    v_exp_f32 v51, v51
    v_perm_b32 v64, v49, v48, s72
    v_exp_f32 v52, v52
    v_perm_b32 v65, v51, v50, s72
    v_mfma_f32_32x32x8_bf16 v[32:47], v[100:101], v[8:9], v[32:47]
    ds_read_b128 v[104:107], v10 offset:11264
    ds_read_b64 v[108:109], v11 offset:14592
    v_exp_f32 v53, v53
    v_exp_f32 v54, v54
    v_exp_f32 v55, v55
    v_perm_b32 v66, v53, v52, s72
    v_exp_f32 v56, v56
    v_perm_b32 v67, v55, v54, s72
    v_exp_f32 v57, v57
    v_exp_f32 v58, v58
    v_mfma_f32_32x32x16_bf16 v[80:95], v[120:123], v[64:67], v[80:95]
    v_exp_f32 v59, v59
    v_perm_b32 v68, v57, v56, s72
    v_exp_f32 v60, v60
    v_exp_f32 v61, v61
    v_exp_f32 v62, v62
    v_exp_f32 v63, v63
    v_perm_b32 v69, v59, v58, s72
    v_perm_b32 v70, v61, v60, s72
    v_perm_b32 v71, v63, v62, s72
    s_barrier
    s_waitcnt lgkmcnt(0)
    v_mfma_f32_32x32x16_bf16 v[48:63], v[104:107], v[4:7], v[16:31]
    v_exp_f32 v32, v32
    v_exp_f32 v33, v33
    v_mfma_f32_32x32x16_bf16 v[80:95], v[124:127], v[68:71], v[80:95]
    s_mov_b64 exec, s[60:61]
    ds_read_b128 v[120:123], v12 offset:16640
    ds_read_b128 v[124:127], v12 offset:17280
    s_mov_b64 exec, -1
    v_exp_f32 v34, v34
    v_exp_f32 v35, v35
    v_perm_b32 v64, v33, v32, s72
    v_exp_f32 v36, v36
    v_perm_b32 v65, v35, v34, s72
    v_mfma_f32_32x32x8_bf16 v[48:63], v[108:109], v[8:9], v[48:63]
    ds_read_b128 v[96:99], v10 offset:12288
    ds_read_b64 v[100:101], v11 offset:14848
    v_exp_f32 v37, v37
    v_exp_f32 v38, v38
    v_exp_f32 v39, v39
    v_perm_b32 v66, v37, v36, s72
    v_exp_f32 v40, v40
    v_perm_b32 v67, v39, v38, s72
    v_exp_f32 v41, v41
    v_exp_f32 v42, v42
    v_mfma_f32_32x32x16_bf16 v[80:95], v[112:115], v[64:67], v[80:95]
    v_exp_f32 v43, v43
    v_perm_b32 v68, v41, v40, s72
    v_exp_f32 v44, v44
    v_exp_f32 v45, v45
    v_exp_f32 v46, v46
    v_exp_f32 v47, v47
    v_perm_b32 v69, v43, v42, s72
    v_perm_b32 v70, v45, v44, s72
    v_perm_b32 v71, v47, v46, s72
    s_waitcnt lgkmcnt(0)
    v_mfma_f32_32x32x16_bf16 v[32:47], v[96:99], v[4:7], v[16:31]
    v_exp_f32 v48, v48
    v_exp_f32 v49, v49
    v_mfma_f32_32x32x16_bf16 v[80:95], v[116:119], v[68:71], v[80:95]
    s_mov_b64 exec, s[60:61]
    ds_read_b128 v[112:115], v12 offset:17920
    ds_read_b128 v[116:119], v12 offset:18560
    s_mov_b64 exec, -1
    v_exp_f32 v50, v50
    v_exp_f32 v51, v51
    v_perm_b32 v64, v49, v48, s72
    v_exp_f32 v52, v52
    v_perm_b32 v65, v51, v50, s72
    v_mfma_f32_32x32x8_bf16 v[32:47], v[100:101], v[8:9], v[32:47]
    ds_read_b128 v[104:107], v10 offset:13312
    ds_read_b64 v[108:109], v11 offset:15104
    v_exp_f32 v53, v53
    v_exp_f32 v54, v54
    v_exp_f32 v55, v55
    v_perm_b32 v66, v53, v52, s72
    v_exp_f32 v56, v56
    v_perm_b32 v67, v55, v54, s72
    v_exp_f32 v57, v57
    v_exp_f32 v58, v58
    v_mfma_f32_32x32x16_bf16 v[80:95], v[120:123], v[64:67], v[80:95]
    v_exp_f32 v59, v59
    v_perm_b32 v68, v57, v56, s72
    v_exp_f32 v60, v60
    v_exp_f32 v61, v61
    v_exp_f32 v62, v62
    v_exp_f32 v63, v63
    v_perm_b32 v69, v59, v58, s72
    v_perm_b32 v70, v61, v60, s72
    v_perm_b32 v71, v63, v62, s72
    s_waitcnt lgkmcnt(0)
    v_mfma_f32_32x32x16_bf16 v[48:63], v[104:107], v[4:7], v[16:31]
    v_exp_f32 v32, v32
    v_exp_f32 v33, v33
    v_mfma_f32_32x32x16_bf16 v[80:95], v[124:127], v[68:71], v[80:95]
    s_mov_b64 exec, s[60:61]
    ds_read_b128 v[120:123], v12 offset:19200
    ds_read_b128 v[124:127], v12 offset:19840
    s_mov_b64 exec, -1
    v_exp_f32 v34, v34
    v_exp_f32 v35, v35
    v_perm_b32 v64, v33, v32, s72
    v_exp_f32 v36, v36
    v_perm_b32 v65, v35, v34, s72
    v_mfma_f32_32x32x8_bf16 v[48:63], v[108:109], v[8:9], v[48:63]
    ds_read_b128 v[96:99], v10 offset:20480
    ds_read_b64 v[100:101], v11 offset:24576
    v_exp_f32 v37, v37
    v_exp_f32 v38, v38
    v_exp_f32 v39, v39
    v_perm_b32 v66, v37, v36, s72
    v_exp_f32 v40, v40
    v_perm_b32 v67, v39, v38, s72
    v_exp_f32 v41, v41
    v_exp_f32 v42, v42
    v_mfma_f32_32x32x16_bf16 v[80:95], v[112:115], v[64:67], v[80:95]
    v_exp_f32 v43, v43
    v_perm_b32 v68, v41, v40, s72
    v_exp_f32 v44, v44
    v_exp_f32 v45, v45
    v_exp_f32 v46, v46
    v_exp_f32 v47, v47
    v_perm_b32 v69, v43, v42, s72
    v_perm_b32 v70, v45, v44, s72
    v_perm_b32 v71, v47, v46, s72
    s_waitcnt lgkmcnt(0)
    v_mfma_f32_32x32x16_bf16 v[32:47], v[96:99], v[4:7], v[16:31]
    v_exp_f32 v48, v48
    v_exp_f32 v49, v49
    v_mfma_f32_32x32x16_bf16 v[80:95], v[116:119], v[68:71], v[80:95]
    s_mov_b64 exec, s[60:61]
    ds_read_b128 v[112:115], v12 offset:25600
    ds_read_b128 v[116:119], v12 offset:26240
    s_mov_b64 exec, -1
    v_exp_f32 v50, v50
    v_exp_f32 v51, v51
    v_perm_b32 v64, v49, v48, s72
    v_exp_f32 v52, v52
    v_perm_b32 v65, v51, v50, s72
    v_mfma_f32_32x32x8_bf16 v[32:47], v[100:101], v[8:9], v[32:47]
    ds_read_b128 v[104:107], v10 offset:21504
    ds_read_b64 v[108:109], v11 offset:24832
    v_exp_f32 v53, v53
    v_exp_f32 v54, v54
    v_exp_f32 v55, v55
    v_perm_b32 v66, v53, v52, s72
    v_exp_f32 v56, v56
    v_perm_b32 v67, v55, v54, s72
    v_exp_f32 v57, v57
    v_exp_f32 v58, v58
    v_mfma_f32_32x32x16_bf16 v[80:95], v[120:123], v[64:67], v[80:95]
    v_exp_f32 v59, v59
    v_perm_b32 v68, v57, v56, s72
    v_exp_f32 v60, v60
    v_exp_f32 v61, v61
    v_exp_f32 v62, v62
    v_exp_f32 v63, v63
    v_perm_b32 v69, v59, v58, s72
    v_perm_b32 v70, v61, v60, s72
    v_perm_b32 v71, v63, v62, s72
    s_barrier
    s_waitcnt lgkmcnt(0)
    v_mfma_f32_32x32x16_bf16 v[48:63], v[104:107], v[4:7], v[16:31]
    v_exp_f32 v32, v32
    v_exp_f32 v33, v33
    v_mfma_f32_32x32x16_bf16 v[80:95], v[124:127], v[68:71], v[80:95]
    s_mov_b64 exec, s[60:61]
    ds_read_b128 v[120:123], v12 offset:26880
    ds_read_b128 v[124:127], v12 offset:27520
    s_mov_b64 exec, -1
    v_exp_f32 v34, v34
    v_exp_f32 v35, v35
    v_perm_b32 v64, v33, v32, s72
    v_exp_f32 v36, v36
    v_perm_b32 v65, v35, v34, s72
    v_mfma_f32_32x32x8_bf16 v[48:63], v[108:109], v[8:9], v[48:63]
    ds_read_b128 v[96:99], v10 offset:22528
    ds_read_b64 v[100:101], v11 offset:25088
    v_exp_f32 v37, v37
    v_exp_f32 v38, v38
    v_exp_f32 v39, v39
    v_perm_b32 v66, v37, v36, s72
    v_exp_f32 v40, v40
    v_perm_b32 v67, v39, v38, s72
    v_exp_f32 v41, v41
    v_exp_f32 v42, v42
    v_mfma_f32_32x32x16_bf16 v[80:95], v[112:115], v[64:67], v[80:95]
    v_exp_f32 v43, v43
    v_perm_b32 v68, v41, v40, s72
    v_exp_f32 v44, v44
    v_exp_f32 v45, v45
    v_exp_f32 v46, v46
    v_exp_f32 v47, v47
    v_perm_b32 v69, v43, v42, s72
    v_perm_b32 v70, v45, v44, s72
    v_perm_b32 v71, v47, v46, s72
    s_waitcnt lgkmcnt(0)
    v_mfma_f32_32x32x16_bf16 v[32:47], v[96:99], v[4:7], v[16:31]
    v_exp_f32 v48, v48
    v_exp_f32 v49, v49
    v_mfma_f32_32x32x16_bf16 v[80:95], v[116:119], v[68:71], v[80:95]
    s_mov_b64 exec, s[60:61]
    ds_read_b128 v[112:115], v12 offset:28160
    ds_read_b128 v[116:119], v12 offset:28800
    s_mov_b64 exec, -1
    v_exp_f32 v50, v50
    v_exp_f32 v51, v51
    v_perm_b32 v64, v49, v48, s72
    v_exp_f32 v52, v52
    v_perm_b32 v65, v51, v50, s72
    v_mfma_f32_32x32x8_bf16 v[32:47], v[100:101], v[8:9], v[32:47]
    ds_read_b128 v[104:107], v10 offset:23552
    ds_read_b64 v[108:109], v11 offset:25344
    v_exp_f32 v53, v53
    v_exp_f32 v54, v54
    v_exp_f32 v55, v55
    v_perm_b32 v66, v53, v52, s72
    v_exp_f32 v56, v56
    v_perm_b32 v67, v55, v54, s72
    v_exp_f32 v57, v57
    v_exp_f32 v58, v58
    v_mfma_f32_32x32x16_bf16 v[80:95], v[120:123], v[64:67], v[80:95]
    v_exp_f32 v59, v59
    v_perm_b32 v68, v57, v56, s72
    v_exp_f32 v60, v60
    v_exp_f32 v61, v61
    v_exp_f32 v62, v62
    v_exp_f32 v63, v63
    v_perm_b32 v69, v59, v58, s72
    v_perm_b32 v70, v61, v60, s72
    v_perm_b32 v71, v63, v62, s72
    s_waitcnt lgkmcnt(0)
    v_mfma_f32_32x32x16_bf16 v[48:63], v[104:107], v[4:7], v[16:31]
    v_exp_f32 v32, v32
    v_exp_f32 v33, v33
    v_mfma_f32_32x32x16_bf16 v[80:95], v[124:127], v[68:71], v[80:95]
    s_mov_b64 exec, s[60:61]
    ds_read_b128 v[120:123], v12 offset:29440
    ds_read_b128 v[124:127], v12 offset:30080
    s_mov_b64 exec, -1
    v_exp_f32 v34, v34
    v_exp_f32 v35, v35
    v_perm_b32 v64, v33, v32, s72
    v_exp_f32 v36, v36
    v_perm_b32 v65, v35, v34, s72
    v_mfma_f32_32x32x8_bf16 v[48:63], v[108:109], v[8:9], v[48:63]
    ds_read_b128 v[96:99], v10 offset:30720
    ds_read_b64 v[100:101], v11 offset:34816
    v_exp_f32 v37, v37
    v_exp_f32 v38, v38
    v_exp_f32 v39, v39
    v_perm_b32 v66, v37, v36, s72
    v_exp_f32 v40, v40
    v_perm_b32 v67, v39, v38, s72
    v_exp_f32 v41, v41
    v_exp_f32 v42, v42
    v_mfma_f32_32x32x16_bf16 v[80:95], v[112:115], v[64:67], v[80:95]
    v_exp_f32 v43, v43
    v_perm_b32 v68, v41, v40, s72
    v_exp_f32 v44, v44
    v_exp_f32 v45, v45
    v_exp_f32 v46, v46
    v_exp_f32 v47, v47
    v_perm_b32 v69, v43, v42, s72
    v_perm_b32 v70, v45, v44, s72
    v_perm_b32 v71, v47, v46, s72
    s_waitcnt lgkmcnt(0)
    v_mfma_f32_32x32x16_bf16 v[32:47], v[96:99], v[4:7], v[16:31]
    v_exp_f32 v48, v48
    v_exp_f32 v49, v49
    v_mfma_f32_32x32x16_bf16 v[80:95], v[116:119], v[68:71], v[80:95]
    s_mov_b64 exec, s[60:61]
    ds_read_b128 v[112:115], v12 offset:35840
    ds_read_b128 v[116:119], v12 offset:36480
    s_mov_b64 exec, -1
    v_exp_f32 v50, v50
    v_exp_f32 v51, v51
    v_perm_b32 v64, v49, v48, s72
    v_exp_f32 v52, v52
    v_perm_b32 v65, v51, v50, s72
    v_mfma_f32_32x32x8_bf16 v[32:47], v[100:101], v[8:9], v[32:47]
    ds_read_b128 v[104:107], v10 offset:31744
    ds_read_b64 v[108:109], v11 offset:35072
    v_exp_f32 v53, v53
    v_exp_f32 v54, v54
    v_exp_f32 v55, v55
    v_perm_b32 v66, v53, v52, s72
    v_exp_f32 v56, v56
    v_perm_b32 v67, v55, v54, s72
    v_exp_f32 v57, v57
    v_exp_f32 v58, v58
    v_mfma_f32_32x32x16_bf16 v[80:95], v[120:123], v[64:67], v[80:95]
    v_exp_f32 v59, v59
    v_perm_b32 v68, v57, v56, s72
    v_exp_f32 v60, v60
    v_exp_f32 v61, v61
    v_exp_f32 v62, v62
    v_exp_f32 v63, v63
    v_perm_b32 v69, v59, v58, s72
    v_perm_b32 v70, v61, v60, s72
    v_perm_b32 v71, v63, v62, s72
    s_cmp_eq_u32 s74, 3
    s_cbranch_scc1 K2_NOBAR3
    s_barrier
K2_NOBAR3:
    s_waitcnt lgkmcnt(0)
    v_mfma_f32_32x32x16_bf16 v[48:63], v[104:107], v[4:7], v[16:31]
    v_exp_f32 v32, v32
    v_exp_f32 v33, v33
    v_mfma_f32_32x32x16_bf16 v[80:95], v[124:127], v[68:71], v[80:95]
    s_mov_b64 exec, s[60:61]
    ds_read_b128 v[120:123], v12 offset:37120
    ds_read_b128 v[124:127], v12 offset:37760
    s_mov_b64 exec, -1
    v_exp_f32 v34, v34
    v_exp_f32 v35, v35
    v_perm_b32 v64, v33, v32, s72
    v_exp_f32 v36, v36
    v_perm_b32 v65, v35, v34, s72
    v_mfma_f32_32x32x8_bf16 v[48:63], v[108:109], v[8:9], v[48:63]
    ds_read_b128 v[96:99], v10 offset:32768
    ds_read_b64 v[100:101], v11 offset:35328
    v_exp_f32 v37, v37
    v_exp_f32 v38, v38
    v_exp_f32 v39, v39
    v_perm_b32 v66, v37, v36, s72
    v_exp_f32 v40, v40
    v_perm_b32 v67, v39, v38, s72
    v_exp_f32 v41, v41
    v_exp_f32 v42, v42
    v_mfma_f32_32x32x16_bf16 v[80:95], v[112:115], v[64:67], v[80:95]
    v_exp_f32 v43, v43
    v_perm_b32 v68, v41, v40, s72
    v_exp_f32 v44, v44
    v_exp_f32 v45, v45
    v_exp_f32 v46, v46
    v_exp_f32 v47, v47
    v_perm_b32 v69, v43, v42, s72
    v_perm_b32 v70, v45, v44, s72
    v_perm_b32 v71, v47, v46, s72
    s_waitcnt lgkmcnt(0)
    v_mfma_f32_32x32x16_bf16 v[32:47], v[96:99], v[4:7], v[16:31]
    v_exp_f32 v48, v48
    v_exp_f32 v49, v49
    v_mfma_f32_32x32x16_bf16 v[80:95], v[116:119], v[68:71], v[80:95]
    s_mov_b64 exec, s[60:61]
    ds_read_b128 v[112:115], v12 offset:38400
    ds_read_b128 v[116:119], v12 offset:39040
    s_mov_b64 exec, -1
    v_exp_f32 v50, v50
    v_exp_f32 v51, v51
    v_perm_b32 v64, v49, v48, s72
    v_exp_f32 v52, v52
    v_perm_b32 v65, v51, v50, s72
    v_mfma_f32_32x32x8_bf16 v[32:47], v[100:101], v[8:9], v[32:47]
    ds_read_b128 v[104:107], v10 offset:33792
    ds_read_b64 v[108:109], v11 offset:35584
    v_exp_f32 v53, v53
    v_exp_f32 v54, v54
    v_exp_f32 v55, v55
    v_perm_b32 v66, v53, v52, s72
    v_exp_f32 v56, v56
    v_perm_b32 v67, v55, v54, s72
    v_exp_f32 v57, v57
    v_exp_f32 v58, v58
    v_mfma_f32_32x32x16_bf16 v[80:95], v[120:123], v[64:67], v[80:95]
    v_exp_f32 v59, v59
    v_perm_b32 v68, v57, v56, s72
    v_exp_f32 v60, v60
    v_exp_f32 v61, v61
    v_exp_f32 v62, v62
    v_exp_f32 v63, v63
    v_perm_b32 v69, v59, v58, s72
    v_perm_b32 v70, v61, v60, s72
    v_perm_b32 v71, v63, v62, s72
    s_waitcnt lgkmcnt(0)
    v_mfma_f32_32x32x16_bf16 v[48:63], v[104:107], v[4:7], v[16:31]
    v_exp_f32 v32, v32
    v_exp_f32 v33, v33
    v_mfma_f32_32x32x16_bf16 v[80:95], v[124:127], v[68:71], v[80:95]
    s_mov_b64 exec, s[60:61]
    ds_read_b128 v[120:123], v12 offset:39680
    ds_read_b128 v[124:127], v12 offset:40320
    s_mov_b64 exec, -1
    v_exp_f32 v34, v34
    v_exp_f32 v35, v35
    v_perm_b32 v64, v33, v32, s72
    v_exp_f32 v36, v36
    v_perm_b32 v65, v35, v34, s72
    v_mfma_f32_32x32x8_bf16 v[48:63], v[108:109], v[8:9], v[48:63]
    ds_read_b128 v[96:99], v10 offset:0
    ds_read_b64 v[100:101], v11 offset:4096
    v_exp_f32 v37, v37
    v_exp_f32 v38, v38
    v_exp_f32 v39, v39
    v_perm_b32 v66, v37, v36, s72
    v_exp_f32 v40, v40
    v_perm_b32 v67, v39, v38, s72
    v_exp_f32 v41, v41
    v_exp_f32 v42, v42
    v_mfma_f32_32x32x16_bf16 v[80:95], v[112:115], v[64:67], v[80:95]
    v_exp_f32 v43, v43
    v_perm_b32 v68, v41, v40, s72
    v_exp_f32 v44, v44
    v_exp_f32 v45, v45
    v_exp_f32 v46, v46
    v_exp_f32 v47, v47
    v_perm_b32 v69, v43, v42, s72
    v_perm_b32 v70, v45, v44, s72
    v_perm_b32 v71, v47, v46, s72
    s_waitcnt lgkmcnt(0)
    v_mfma_f32_32x32x16_bf16 v[32:47], v[96:99], v[4:7], v[16:31]
    v_exp_f32 v48, v48
    v_exp_f32 v49, v49
    v_mfma_f32_32x32x16_bf16 v[80:95], v[116:119], v[68:71], v[80:95]
    s_mov_b64 exec, s[60:61]
    ds_read_b128 v[112:115], v12 offset:5120
    ds_read_b128 v[116:119], v12 offset:5760
    s_mov_b64 exec, -1
    v_exp_f32 v50, v50
    v_exp_f32 v51, v51
    v_perm_b32 v64, v49, v48, s72
    v_exp_f32 v52, v52
    v_perm_b32 v65, v51, v50, s72
    v_mfma_f32_32x32x8_bf16 v[32:47], v[100:101], v[8:9], v[32:47]
    ds_read_b128 v[104:107], v10 offset:1024
    ds_read_b64 v[108:109], v11 offset:4352
    v_exp_f32 v53, v53
    v_exp_f32 v54, v54
    v_exp_f32 v55, v55
    v_perm_b32 v66, v53, v52, s72
    v_exp_f32 v56, v56
    v_perm_b32 v67, v55, v54, s72
    v_exp_f32 v57, v57
    v_exp_f32 v58, v58
    v_mfma_f32_32x32x16_bf16 v[80:95], v[120:123], v[64:67], v[80:95]
    v_exp_f32 v59, v59
    v_perm_b32 v68, v57, v56, s72
    v_exp_f32 v60, v60
    v_exp_f32 v61, v61
    v_exp_f32 v62, v62
    v_exp_f32 v63, v63
    v_perm_b32 v69, v59, v58, s72
    v_perm_b32 v70, v61, v60, s72
    v_perm_b32 v71, v63, v62, s72
    s_add_u32 s74, s74, 1
    s_cmp_lt_u32 s74, 4
    s_cbranch_scc1 K2_LOOP
    s_nop 1

    v_mfma_f32_32x32x16_bf16 v[80:95], v[124:127], v[68:71], v[80:95]
    s_waitcnt lgkmcnt(0)
    s_nop 15
    v_mov_b32 v14, 0
    v_fma_f32 v14, v80, 0, v14
    v_fma_f32 v14, v81, 0, v14
    v_fma_f32 v14, v82, 0, v14
    v_fma_f32 v14, v83, 0, v14
    v_fma_f32 v14, v84, 0, v14
    v_fma_f32 v14, v85, 0, v14
    v_fma_f32 v14, v86, 0, v14
    v_fma_f32 v14, v87, 0, v14
    v_fma_f32 v14, v88, 0, v14
    v_fma_f32 v14, v89, 0, v14
    v_fma_f32 v14, v90, 0, v14
    v_fma_f32 v14, v91, 0, v14
    v_mov_b32 v15, 0x5f800000
    v_cmp_gt_u32 vcc, 32, v1
    s_nop 1
    v_cndmask_b32 v13, v88, 0, vcc
    v_add_f32 v13, v13, v14
    v_cmp_nle_f32 vcc, v13, v15
    s_nop 4
    s_cbranch_vccz K2_FIN

    s_add_u32 s22, s20, 2621440
    s_addc_u32 s23, s21, 0
    s_mov_b32 s28, s22
    s_and_b32 s29, s23, 0xffff
    s_mov_b32 s30, 2621440
    s_mov_b32 s31, 0x20000
    s_add_u32 s22, s20, 10485760
    s_addc_u32 s23, s21, 0
    s_mov_b32 s32, s22
    s_and_b32 s33, s23, 0xffff
    s_mov_b32 s34, 2621440
    s_mov_b32 s35, 0x20000
    v_lshlrev_b32 v10, 4, v1
    v_and_b32 v2, 31, v1
    v_lshlrev_b32 v11, 4, v2
    v_lshrrev_b32 v3, 5, v1
    v_mul_u32_u24 v12, 320, v3
    v_add_u32 v12, v12, v11
    v_mov_b32 v13, 0xff800000
    s_mov_b32 s74, 0
    s_mov_b32 s62, s12
    s_mov_b32 s63, s13
K2_MAXLOOP:
    buffer_load_dwordx4 v[96:99], v10, s[28:31], s62 offen
    buffer_load_dwordx2 v[100:101], v11, s[28:31], s63 offen
    s_waitcnt vmcnt(0)

    v_mfma_f32_32x32x16_bf16 v[32:47], v[96:99], v[4:7], 0
    v_mfma_f32_32x32x8_bf16 v[32:47], v[100:101], v[8:9], v[32:47]
    s_nop 15
    v_max3_f32 v13, v13, v32, v33
    v_max3_f32 v13, v13, v34, v35
    v_max3_f32 v13, v13, v36, v37
    v_max3_f32 v13, v13, v38, v39
    v_max3_f32 v13, v13, v40, v41
    v_max3_f32 v13, v13, v42, v43
    v_max3_f32 v13, v13, v44, v45
    v_max3_f32 v13, v13, v46, v47
    s_add_u32 s62, s62, 40960
    s_add_u32 s63, s63, 40960
    s_add_u32 s74, s74, 1
    s_cmp_lt_u32 s74, 64
    s_cbranch_scc1 K2_MAXLOOP

    v_mov_b32 v14, v13
    s_nop 1
    v_permlane32_swap_b32 v13, v14
    s_nop 1
    v_max_f32 v13, v13, v14
    v_sub_f32 v16, 0, v13
    v_sub_f32 v17, 0, v13
    v_sub_f32 v18, 0, v13
    v_sub_f32 v19, 0, v13
    v_sub_f32 v20, 0, v13
    v_sub_f32 v21, 0, v13
    v_sub_f32 v22, 0, v13
    v_sub_f32 v23, 0, v13
    v_sub_f32 v24, 0, v13
    v_sub_f32 v25, 0, v13
    v_sub_f32 v26, 0, v13
    v_sub_f32 v27, 0, v13
    v_sub_f32 v28, 0, v13
    v_sub_f32 v29, 0, v13
    v_sub_f32 v30, 0, v13
    v_sub_f32 v31, 0, v13
    v_mov_b32 v80, 0
    v_mov_b32 v81, 0
    v_mov_b32 v82, 0
    v_mov_b32 v83, 0
    v_mov_b32 v84, 0
    v_mov_b32 v85, 0
    v_mov_b32 v86, 0
    v_mov_b32 v87, 0
    v_mov_b32 v88, 0
    v_mov_b32 v89, 0
    v_mov_b32 v90, 0
    v_mov_b32 v91, 0
    v_mov_b32 v92, 0
    v_mov_b32 v93, 0
    v_mov_b32 v94, 0
    v_mov_b32 v95, 0
    s_mov_b32 s74, 0
    s_mov_b32 s62, s12
    s_mov_b32 s63, s13
    s_mov_b32 s64, s16
K2_SLOWLOOP:
    buffer_load_dwordx4 v[96:99], v10, s[28:31], s62 offen
    buffer_load_dwordx2 v[100:101], v11, s[28:31], s63 offen
    s_mov_b64 exec, s[60:61]
    buffer_load_dwordx4 v[112:115], v12, s[32:35], s64 offen
    buffer_load_dwordx4 v[116:119], v12, s[32:35], s64 offen offset:640
    s_mov_b64 exec, -1
    s_waitcnt vmcnt(0)

    v_mfma_f32_32x32x16_bf16 v[32:47], v[96:99], v[4:7], v[16:31]
    v_mfma_f32_32x32x8_bf16 v[32:47], v[100:101], v[8:9], v[32:47]
    s_nop 15
    v_exp_f32 v32, v32
    v_exp_f32 v33, v33
    v_exp_f32 v34, v34
    v_exp_f32 v35, v35
    v_exp_f32 v36, v36
    v_exp_f32 v37, v37
    v_exp_f32 v38, v38
    v_exp_f32 v39, v39
    v_exp_f32 v40, v40
    v_exp_f32 v41, v41
    v_exp_f32 v42, v42
    v_exp_f32 v43, v43
    v_exp_f32 v44, v44
    v_exp_f32 v45, v45
    v_exp_f32 v46, v46
    v_exp_f32 v47, v47
    s_nop 0
    v_cvt_pk_bf16_f32 v64, v32, v33
    v_cvt_pk_bf16_f32 v65, v34, v35
    v_cvt_pk_bf16_f32 v66, v36, v37
    v_cvt_pk_bf16_f32 v67, v38, v39
    v_cvt_pk_bf16_f32 v68, v40, v41
    v_cvt_pk_bf16_f32 v69, v42, v43
    v_cvt_pk_bf16_f32 v70, v44, v45
    v_cvt_pk_bf16_f32 v71, v46, v47
    s_nop 1
    v_mfma_f32_32x32x16_bf16 v[80:95], v[112:115], v[64:67], v[80:95]
    v_mfma_f32_32x32x16_bf16 v[80:95], v[116:119], v[68:71], v[80:95]
    s_add_u32 s62, s62, 40960
    s_add_u32 s63, s63, 40960
    s_add_u32 s64, s64, 1280
    s_add_u32 s74, s74, 1
    s_cmp_lt_u32 s74, 64
    s_cbranch_scc1 K2_SLOWLOOP
    s_nop 15

K2_FIN:
    v_mov_b32 v13, v88
    v_mov_b32 v14, v88
    s_nop 1
    v_permlane32_swap_b32 v13, v14
    s_nop 1
    v_rcp_f32 v14, v14
    s_nop 1

    v_mul_f32 v80, v80, v14
    v_mul_f32 v81, v81, v14
    v_mul_f32 v82, v82, v14
    v_mul_f32 v83, v83, v14
    v_mul_f32 v84, v84, v14
    v_mul_f32 v85, v85, v14
    v_mul_f32 v86, v86, v14
    v_mul_f32 v87, v87, v14
    v_mul_f32 v88, v88, v14
    v_mul_f32 v89, v89, v14
    v_mul_f32 v90, v90, v14
    v_mul_f32 v91, v91, v14
    v_cvt_pk_bf16_f32 v64, v80, v81
    v_cvt_pk_bf16_f32 v65, v82, v83
    v_cvt_pk_bf16_f32 v66, v84, v85
    v_cvt_pk_bf16_f32 v67, v86, v87
    v_cvt_pk_bf16_f32 v68, v88, v89
    v_cvt_pk_bf16_f32 v69, v90, v91
    v_lshlrev_b32 v13, 4, v1
    buffer_store_dwordx4 v[64:67], v13, s[36:39], s70 offen sc1
    v_mov_b32 v15, 0x40000000
    v_cmp_gt_u32 vcc, 32, v1
    s_nop 1
    v_cndmask_b32 v15, v15, v13, vcc
    buffer_store_dwordx2 v[68:69], v15, s[36:39], s71 offen sc1

K2_END:
    s_endpgm
    .globl k3_proj_kernel
    .p2align 8
    .type k3_proj_kernel,@function
k3_proj_kernel:
    s_cmp_ge_u32 s2, 256
    s_cbranch_scc1 K3_END
    s_load_dwordx2 s[16:17], s[0:1], 48
    s_load_dwordx2 s[20:21], s[0:1], 64

    s_and_b32 s3, s2, 7
    s_lshr_b32 s4, s2, 3
    s_lshr_b32 s5, s3, 2
    s_and_b32 s6, s3, 3
    s_lshl_b32 s6, s6, 2
    s_and_b32 s7, s4, 3
    s_add_u32 s8, s6, s7
    s_lshr_b32 s9, s4, 2
    v_lshrrev_b32 v1, 6, v0
    v_and_b32 v2, 63, v0
    s_lshl_b32 s10, s5, 3
    v_readfirstlane_b32 s11, v1
    s_add_u32 s10, s10, s9
    s_mul_i32 s10, s10, 102400
    v_lshlrev_b32 v3, 4, v2
    s_add_u32 s12, s9, s7
    s_lshl_b32 s12, s12, 2
    s_mov_b32 s14, 0x21043210
    s_mov_b32 s15, 0x043
    s_lshr_b64 s[14:15], s[14:15], s12
    s_and_b32 s13, s14, 0
    s_cmp_ge_u32 s11, 4
    s_cbranch_scc0 K3_COMPUTE

    s_sub_u32 s12, s11, 4
    s_lshl_b32 s35, s12, 10
    s_add_u32 s34, s10, s35
    s_waitcnt lgkmcnt(0)
    s_add_u32 s22, s20, 20971520
    s_addc_u32 s23, s21, 0

    s_mov_b32 s28, s22
    s_and_b32 s29, s23, 0xffff
    s_mov_b32 s30, 1638400
    s_mov_b32 s31, 0x20000
    s_mul_i32 s37, s13, 20480
    s_add_u32 s38, s34, s37
    s_add_u32 m0, s35, 0
    s_add_u32 s36, s38, 0
    buffer_load_dwordx4 v3, s[28:31], s36 offen lds
    s_add_u32 m0, s35, 4096
    s_add_u32 s36, s38, 4096
    buffer_load_dwordx4 v3, s[28:31], s36 offen lds
    s_add_u32 m0, s35, 8192
    s_add_u32 s36, s38, 8192
    buffer_load_dwordx4 v3, s[28:31], s36 offen lds
    s_add_u32 m0, s35, 12288
    s_add_u32 s36, s38, 12288
    buffer_load_dwordx4 v3, s[28:31], s36 offen lds
    s_add_u32 m0, s35, 16384
    s_add_u32 s36, s38, 16384
    buffer_load_dwordx4 v3, s[28:31], s36 offen lds
    s_add_u32 s37, s37, 20480
    s_cmp_eq_u32 s37, 102400
    s_cselect_b32 s37, 0, s37
    s_waitcnt vmcnt(0)
    s_barrier
    s_add_u32 s38, s34, s37
    s_add_u32 m0, s35, 20480
    s_add_u32 s36, s38, 0
    buffer_load_dwordx4 v3, s[28:31], s36 offen lds
    s_add_u32 m0, s35, 24576
    s_add_u32 s36, s38, 4096
    buffer_load_dwordx4 v3, s[28:31], s36 offen lds
    s_add_u32 m0, s35, 28672
    s_add_u32 s36, s38, 8192
    buffer_load_dwordx4 v3, s[28:31], s36 offen lds
    s_add_u32 m0, s35, 32768
    s_add_u32 s36, s38, 12288
    buffer_load_dwordx4 v3, s[28:31], s36 offen lds
    s_add_u32 m0, s35, 36864
    s_add_u32 s36, s38, 16384
    buffer_load_dwordx4 v3, s[28:31], s36 offen lds
    s_add_u32 s37, s37, 20480
    s_cmp_eq_u32 s37, 102400
    s_cselect_b32 s37, 0, s37
    s_add_u32 s38, s34, s37
    s_add_u32 m0, s35, 40960
    s_add_u32 s36, s38, 0
    buffer_load_dwordx4 v3, s[28:31], s36 offen lds
    s_add_u32 m0, s35, 45056
    s_add_u32 s36, s38, 4096
    buffer_load_dwordx4 v3, s[28:31], s36 offen lds
    s_add_u32 m0, s35, 49152
    s_add_u32 s36, s38, 8192
    buffer_load_dwordx4 v3, s[28:31], s36 offen lds
    s_add_u32 m0, s35, 53248
    s_add_u32 s36, s38, 12288
    buffer_load_dwordx4 v3, s[28:31], s36 offen lds
    s_add_u32 m0, s35, 57344
    s_add_u32 s36, s38, 16384
    buffer_load_dwordx4 v3, s[28:31], s36 offen lds
    s_add_u32 s37, s37, 20480
    s_cmp_eq_u32 s37, 102400
    s_cselect_b32 s37, 0, s37
    s_waitcnt vmcnt(5)
    s_barrier
    s_add_u32 s38, s34, s37
    s_add_u32 m0, s35, 61440
    s_add_u32 s36, s38, 0
    buffer_load_dwordx4 v3, s[28:31], s36 offen lds
    s_add_u32 m0, s35, 65536
    s_add_u32 s36, s38, 4096
    buffer_load_dwordx4 v3, s[28:31], s36 offen lds
    s_add_u32 m0, s35, 69632
    s_add_u32 s36, s38, 8192
    buffer_load_dwordx4 v3, s[28:31], s36 offen lds
    s_add_u32 m0, s35, 73728
    s_add_u32 s36, s38, 12288
    buffer_load_dwordx4 v3, s[28:31], s36 offen lds
    s_add_u32 m0, s35, 77824
    s_add_u32 s36, s38, 16384
    buffer_load_dwordx4 v3, s[28:31], s36 offen lds
    s_add_u32 s37, s37, 20480
    s_cmp_eq_u32 s37, 102400
    s_cselect_b32 s37, 0, s37
    s_waitcnt vmcnt(5)
    s_barrier
    s_add_u32 s38, s34, s37
    s_add_u32 m0, s35, 81920
    s_add_u32 s36, s38, 0
    buffer_load_dwordx4 v3, s[28:31], s36 offen lds
    s_add_u32 m0, s35, 86016
    s_add_u32 s36, s38, 4096
    buffer_load_dwordx4 v3, s[28:31], s36 offen lds
    s_add_u32 m0, s35, 90112
    s_add_u32 s36, s38, 8192
    buffer_load_dwordx4 v3, s[28:31], s36 offen lds
    s_add_u32 m0, s35, 94208
    s_add_u32 s36, s38, 12288
    buffer_load_dwordx4 v3, s[28:31], s36 offen lds
    s_add_u32 m0, s35, 98304
    s_add_u32 s36, s38, 16384
    buffer_load_dwordx4 v3, s[28:31], s36 offen lds
    s_add_u32 s37, s37, 20480
    s_cmp_eq_u32 s37, 102400
    s_cselect_b32 s37, 0, s37
    s_waitcnt vmcnt(5)
    s_barrier
    s_waitcnt vmcnt(0)
    s_barrier
    s_endpgm
K3_COMPUTE:
    v_mov_b32 v112, v2
    v_lshrrev_b32 v4, 4, v2
    v_and_b32 v5, 15, v2
    v_lshlrev_b32 v4, 9, v4
    v_lshl_add_u32 v113, v5, 4, v4
    s_mul_i32 s43, s5, 2621440
    s_lshl_b32 s46, s8, 2
    s_add_u32 s46, s46, s11
    s_mul_i32 s47, s46, 40960
    s_add_u32 s43, s43, 15728640
    s_waitcnt lgkmcnt(0)
    s_add_u32 s44, s20, s43
    s_addc_u32 s45, s21, 0

    s_mov_b32 s24, s44
    s_and_b32 s25, s45, 0xffff
    s_mov_b32 s26, 2621440
    s_mov_b32 s27, 0x20000
    s_lshl_b32 s49, s13, 13
    s_add_u32 s48, s47, s49
    s_add_u32 s49, s49, 2048
    s_cmp_eq_u32 s49, 40960
    s_cselect_b32 s49, 0, s49
    buffer_load_dwordx4 v[80:83], v113, s[24:27], s48 offen
    buffer_load_dwordx4 v[84:87], v113, s[24:27], s48 offen offset:256
    s_add_u32 s48, s47, s49
    s_add_u32 s49, s49, 2048
    s_cmp_eq_u32 s49, 40960
    s_cselect_b32 s49, 0, s49
    buffer_load_dwordx4 v[88:91], v113, s[24:27], s48 offen
    buffer_load_dwordx4 v[92:95], v113, s[24:27], s48 offen offset:256
    v_mov_b32 v114, v3
    v_add_u32 v115, 51200, v3
    v_mov_b32 v0, 0
    v_mov_b32 v1, 0
    v_mov_b32 v2, 0
    v_mov_b32 v3, 0
    v_mov_b32 v4, 0
    v_mov_b32 v5, 0
    v_mov_b32 v6, 0
    v_mov_b32 v7, 0
    v_mov_b32 v8, 0
    v_mov_b32 v9, 0
    v_mov_b32 v10, 0
    v_mov_b32 v11, 0
    v_mov_b32 v12, 0
    v_mov_b32 v13, 0
    v_mov_b32 v14, 0
    v_mov_b32 v15, 0
    v_mov_b32 v16, 0
    v_mov_b32 v17, 0
    v_mov_b32 v18, 0
    v_mov_b32 v19, 0
    v_mov_b32 v20, 0
    v_mov_b32 v21, 0
    v_mov_b32 v22, 0
    v_mov_b32 v23, 0
    v_mov_b32 v24, 0
    v_mov_b32 v25, 0
    v_mov_b32 v26, 0
    v_mov_b32 v27, 0
    v_mov_b32 v28, 0
    v_mov_b32 v29, 0
    v_mov_b32 v30, 0
    v_mov_b32 v31, 0
    v_mov_b32 v32, 0
    v_mov_b32 v33, 0
    v_mov_b32 v34, 0
    v_mov_b32 v35, 0
    v_mov_b32 v36, 0
    v_mov_b32 v37, 0
    v_mov_b32 v38, 0
    v_mov_b32 v39, 0
    s_barrier
    s_add_u32 s48, s47, s49
    s_add_u32 s49, s49, 2048
    s_cmp_eq_u32 s49, 40960
    s_cselect_b32 s49, 0, s49
    buffer_load_dwordx4 v[96:99], v113, s[24:27], s48 offen
    buffer_load_dwordx4 v[100:103], v113, s[24:27], s48 offen offset:256
    s_add_u32 s48, s47, s49
    s_add_u32 s49, s49, 2048
    s_cmp_eq_u32 s49, 40960
    s_cselect_b32 s49, 0, s49
    buffer_load_dwordx4 v[104:107], v113, s[24:27], s48 offen
    buffer_load_dwordx4 v[108:111], v113, s[24:27], s48 offen offset:256
    ds_read_b128 v[40:43], v114 offset:0
    ds_read_b128 v[44:47], v114 offset:1024
    ds_read_b128 v[48:51], v114 offset:2048
    ds_read_b128 v[52:55], v114 offset:3072
    ds_read_b128 v[56:59], v114 offset:4096
    s_waitcnt lgkmcnt(0)
    s_waitcnt vmcnt(6)
    v_mfma_f32_16x16x32_bf16 v[0:3], v[40:43], v[80:83], v[0:3]
    v_mfma_f32_16x16x32_bf16 v[20:23], v[40:43], v[84:87], v[20:23]
    ds_read_b128 v[60:63], v114 offset:5120
    v_mfma_f32_16x16x32_bf16 v[4:7], v[44:47], v[80:83], v[4:7]
    v_mfma_f32_16x16x32_bf16 v[24:27], v[44:47], v[84:87], v[24:27]
    ds_read_b128 v[64:67], v114 offset:6144
    v_mfma_f32_16x16x32_bf16 v[8:11], v[48:51], v[80:83], v[8:11]
    v_mfma_f32_16x16x32_bf16 v[28:31], v[48:51], v[84:87], v[28:31]
    ds_read_b128 v[68:71], v114 offset:7168
    v_mfma_f32_16x16x32_bf16 v[12:15], v[52:55], v[80:83], v[12:15]
    v_mfma_f32_16x16x32_bf16 v[32:35], v[52:55], v[84:87], v[32:35]
    ds_read_b128 v[72:75], v114 offset:8192
    v_mfma_f32_16x16x32_bf16 v[16:19], v[56:59], v[80:83], v[16:19]
    v_mfma_f32_16x16x32_bf16 v[36:39], v[56:59], v[84:87], v[36:39]
    ds_read_b128 v[76:79], v114 offset:9216
    s_add_u32 s48, s47, s49
    s_add_u32 s49, s49, 2048
    s_cmp_eq_u32 s49, 40960
    s_cselect_b32 s49, 0, s49
    buffer_load_dwordx4 v[80:83], v113, s[24:27], s48 offen
    buffer_load_dwordx4 v[84:87], v113, s[24:27], s48 offen offset:256
    s_waitcnt lgkmcnt(0)
    s_waitcnt vmcnt(6)
    v_mfma_f32_16x16x32_bf16 v[0:3], v[60:63], v[88:91], v[0:3]
    v_mfma_f32_16x16x32_bf16 v[20:23], v[60:63], v[92:95], v[20:23]
    ds_read_b128 v[40:43], v114 offset:10240
    v_mfma_f32_16x16x32_bf16 v[4:7], v[64:67], v[88:91], v[4:7]
    v_mfma_f32_16x16x32_bf16 v[24:27], v[64:67], v[92:95], v[24:27]
    ds_read_b128 v[44:47], v114 offset:11264
    v_mfma_f32_16x16x32_bf16 v[8:11], v[68:71], v[88:91], v[8:11]
    v_mfma_f32_16x16x32_bf16 v[28:31], v[68:71], v[92:95], v[28:31]
    ds_read_b128 v[48:51], v114 offset:12288
    v_mfma_f32_16x16x32_bf16 v[12:15], v[72:75], v[88:91], v[12:15]
    v_mfma_f32_16x16x32_bf16 v[32:35], v[72:75], v[92:95], v[32:35]
    ds_read_b128 v[52:55], v114 offset:13312
    v_mfma_f32_16x16x32_bf16 v[16:19], v[76:79], v[88:91], v[16:19]
    v_mfma_f32_16x16x32_bf16 v[36:39], v[76:79], v[92:95], v[36:39]
    ds_read_b128 v[56:59], v114 offset:14336
    s_add_u32 s48, s47, s49
    s_add_u32 s49, s49, 2048
    s_cmp_eq_u32 s49, 40960
    s_cselect_b32 s49, 0, s49
    buffer_load_dwordx4 v[88:91], v113, s[24:27], s48 offen
    buffer_load_dwordx4 v[92:95], v113, s[24:27], s48 offen offset:256
    s_waitcnt lgkmcnt(0)
    s_waitcnt vmcnt(6)
    v_mfma_f32_16x16x32_bf16 v[0:3], v[40:43], v[96:99], v[0:3]
    v_mfma_f32_16x16x32_bf16 v[20:23], v[40:43], v[100:103], v[20:23]
    ds_read_b128 v[60:63], v114 offset:15360
    v_mfma_f32_16x16x32_bf16 v[4:7], v[44:47], v[96:99], v[4:7]
    v_mfma_f32_16x16x32_bf16 v[24:27], v[44:47], v[100:103], v[24:27]
    ds_read_b128 v[64:67], v114 offset:16384
    v_mfma_f32_16x16x32_bf16 v[8:11], v[48:51], v[96:99], v[8:11]
    v_mfma_f32_16x16x32_bf16 v[28:31], v[48:51], v[100:103], v[28:31]
    ds_read_b128 v[68:71], v114 offset:17408
    v_mfma_f32_16x16x32_bf16 v[12:15], v[52:55], v[96:99], v[12:15]
    v_mfma_f32_16x16x32_bf16 v[32:35], v[52:55], v[100:103], v[32:35]
    ds_read_b128 v[72:75], v114 offset:18432
    v_mfma_f32_16x16x32_bf16 v[16:19], v[56:59], v[96:99], v[16:19]
    v_mfma_f32_16x16x32_bf16 v[36:39], v[56:59], v[100:103], v[36:39]
    ds_read_b128 v[76:79], v114 offset:19456
    s_add_u32 s48, s47, s49
    s_add_u32 s49, s49, 2048
    s_cmp_eq_u32 s49, 40960
    s_cselect_b32 s49, 0, s49
    buffer_load_dwordx4 v[96:99], v113, s[24:27], s48 offen
    buffer_load_dwordx4 v[100:103], v113, s[24:27], s48 offen offset:256
    s_waitcnt lgkmcnt(0)
    s_barrier
    s_waitcnt vmcnt(6)
    v_mfma_f32_16x16x32_bf16 v[0:3], v[60:63], v[104:107], v[0:3]
    v_mfma_f32_16x16x32_bf16 v[20:23], v[60:63], v[108:111], v[20:23]
    ds_read_b128 v[40:43], v114 offset:20480
    v_mfma_f32_16x16x32_bf16 v[4:7], v[64:67], v[104:107], v[4:7]
    v_mfma_f32_16x16x32_bf16 v[24:27], v[64:67], v[108:111], v[24:27]
    ds_read_b128 v[44:47], v114 offset:21504
    v_mfma_f32_16x16x32_bf16 v[8:11], v[68:71], v[104:107], v[8:11]
    v_mfma_f32_16x16x32_bf16 v[28:31], v[68:71], v[108:111], v[28:31]
    ds_read_b128 v[48:51], v114 offset:22528
    v_mfma_f32_16x16x32_bf16 v[12:15], v[72:75], v[104:107], v[12:15]
    v_mfma_f32_16x16x32_bf16 v[32:35], v[72:75], v[108:111], v[32:35]
    ds_read_b128 v[52:55], v114 offset:23552
    v_mfma_f32_16x16x32_bf16 v[16:19], v[76:79], v[104:107], v[16:19]
    v_mfma_f32_16x16x32_bf16 v[36:39], v[76:79], v[108:111], v[36:39]
    ds_read_b128 v[56:59], v114 offset:24576
    s_add_u32 s48, s47, s49
    s_add_u32 s49, s49, 2048
    s_cmp_eq_u32 s49, 40960
    s_cselect_b32 s49, 0, s49
    buffer_load_dwordx4 v[104:107], v113, s[24:27], s48 offen
    buffer_load_dwordx4 v[108:111], v113, s[24:27], s48 offen offset:256
    s_waitcnt lgkmcnt(0)
    s_waitcnt vmcnt(6)
    v_mfma_f32_16x16x32_bf16 v[0:3], v[40:43], v[80:83], v[0:3]
    v_mfma_f32_16x16x32_bf16 v[20:23], v[40:43], v[84:87], v[20:23]
    ds_read_b128 v[60:63], v114 offset:25600
    v_mfma_f32_16x16x32_bf16 v[4:7], v[44:47], v[80:83], v[4:7]
    v_mfma_f32_16x16x32_bf16 v[24:27], v[44:47], v[84:87], v[24:27]
    ds_read_b128 v[64:67], v114 offset:26624
    v_mfma_f32_16x16x32_bf16 v[8:11], v[48:51], v[80:83], v[8:11]
    v_mfma_f32_16x16x32_bf16 v[28:31], v[48:51], v[84:87], v[28:31]
    ds_read_b128 v[68:71], v114 offset:27648
    v_mfma_f32_16x16x32_bf16 v[12:15], v[52:55], v[80:83], v[12:15]
    v_mfma_f32_16x16x32_bf16 v[32:35], v[52:55], v[84:87], v[32:35]
    ds_read_b128 v[72:75], v114 offset:28672
    v_mfma_f32_16x16x32_bf16 v[16:19], v[56:59], v[80:83], v[16:19]
    v_mfma_f32_16x16x32_bf16 v[36:39], v[56:59], v[84:87], v[36:39]
    ds_read_b128 v[76:79], v114 offset:29696
    s_add_u32 s48, s47, s49
    s_add_u32 s49, s49, 2048
    s_cmp_eq_u32 s49, 40960
    s_cselect_b32 s49, 0, s49
    buffer_load_dwordx4 v[80:83], v113, s[24:27], s48 offen
    buffer_load_dwordx4 v[84:87], v113, s[24:27], s48 offen offset:256
    s_waitcnt lgkmcnt(0)
    s_waitcnt vmcnt(6)
    v_mfma_f32_16x16x32_bf16 v[0:3], v[60:63], v[88:91], v[0:3]
    v_mfma_f32_16x16x32_bf16 v[20:23], v[60:63], v[92:95], v[20:23]
    ds_read_b128 v[40:43], v114 offset:30720
    v_mfma_f32_16x16x32_bf16 v[4:7], v[64:67], v[88:91], v[4:7]
    v_mfma_f32_16x16x32_bf16 v[24:27], v[64:67], v[92:95], v[24:27]
    ds_read_b128 v[44:47], v114 offset:31744
    v_mfma_f32_16x16x32_bf16 v[8:11], v[68:71], v[88:91], v[8:11]
    v_mfma_f32_16x16x32_bf16 v[28:31], v[68:71], v[92:95], v[28:31]
    ds_read_b128 v[48:51], v114 offset:32768
    v_mfma_f32_16x16x32_bf16 v[12:15], v[72:75], v[88:91], v[12:15]
    v_mfma_f32_16x16x32_bf16 v[32:35], v[72:75], v[92:95], v[32:35]
    ds_read_b128 v[52:55], v114 offset:33792
    v_mfma_f32_16x16x32_bf16 v[16:19], v[76:79], v[88:91], v[16:19]
    v_mfma_f32_16x16x32_bf16 v[36:39], v[76:79], v[92:95], v[36:39]
    ds_read_b128 v[56:59], v114 offset:34816
    s_add_u32 s48, s47, s49
    s_add_u32 s49, s49, 2048
    s_cmp_eq_u32 s49, 40960
    s_cselect_b32 s49, 0, s49
    buffer_load_dwordx4 v[88:91], v113, s[24:27], s48 offen
    buffer_load_dwordx4 v[92:95], v113, s[24:27], s48 offen offset:256
    s_waitcnt lgkmcnt(0)
    s_waitcnt vmcnt(6)
    v_mfma_f32_16x16x32_bf16 v[0:3], v[40:43], v[96:99], v[0:3]
    v_mfma_f32_16x16x32_bf16 v[20:23], v[40:43], v[100:103], v[20:23]
    ds_read_b128 v[60:63], v114 offset:35840
    v_mfma_f32_16x16x32_bf16 v[4:7], v[44:47], v[96:99], v[4:7]
    v_mfma_f32_16x16x32_bf16 v[24:27], v[44:47], v[100:103], v[24:27]
    ds_read_b128 v[64:67], v114 offset:36864
    v_mfma_f32_16x16x32_bf16 v[8:11], v[48:51], v[96:99], v[8:11]
    v_mfma_f32_16x16x32_bf16 v[28:31], v[48:51], v[100:103], v[28:31]
    ds_read_b128 v[68:71], v114 offset:37888
    v_mfma_f32_16x16x32_bf16 v[12:15], v[52:55], v[96:99], v[12:15]
    v_mfma_f32_16x16x32_bf16 v[32:35], v[52:55], v[100:103], v[32:35]
    ds_read_b128 v[72:75], v114 offset:38912
    v_mfma_f32_16x16x32_bf16 v[16:19], v[56:59], v[96:99], v[16:19]
    v_mfma_f32_16x16x32_bf16 v[36:39], v[56:59], v[100:103], v[36:39]
    ds_read_b128 v[76:79], v114 offset:39936
    s_add_u32 s48, s47, s49
    s_add_u32 s49, s49, 2048
    s_cmp_eq_u32 s49, 40960
    s_cselect_b32 s49, 0, s49
    buffer_load_dwordx4 v[96:99], v113, s[24:27], s48 offen
    buffer_load_dwordx4 v[100:103], v113, s[24:27], s48 offen offset:256
    s_waitcnt lgkmcnt(0)
    s_barrier
    s_waitcnt vmcnt(6)
    v_mfma_f32_16x16x32_bf16 v[0:3], v[60:63], v[104:107], v[0:3]
    v_mfma_f32_16x16x32_bf16 v[20:23], v[60:63], v[108:111], v[20:23]
    ds_read_b128 v[40:43], v114 offset:40960
    v_mfma_f32_16x16x32_bf16 v[4:7], v[64:67], v[104:107], v[4:7]
    v_mfma_f32_16x16x32_bf16 v[24:27], v[64:67], v[108:111], v[24:27]
    ds_read_b128 v[44:47], v114 offset:41984
    v_mfma_f32_16x16x32_bf16 v[8:11], v[68:71], v[104:107], v[8:11]
    v_mfma_f32_16x16x32_bf16 v[28:31], v[68:71], v[108:111], v[28:31]
    ds_read_b128 v[48:51], v114 offset:43008
    v_mfma_f32_16x16x32_bf16 v[12:15], v[72:75], v[104:107], v[12:15]
    v_mfma_f32_16x16x32_bf16 v[32:35], v[72:75], v[108:111], v[32:35]
    ds_read_b128 v[52:55], v114 offset:44032
    v_mfma_f32_16x16x32_bf16 v[16:19], v[76:79], v[104:107], v[16:19]
    v_mfma_f32_16x16x32_bf16 v[36:39], v[76:79], v[108:111], v[36:39]
    ds_read_b128 v[56:59], v114 offset:45056
    s_add_u32 s48, s47, s49
    s_add_u32 s49, s49, 2048
    s_cmp_eq_u32 s49, 40960
    s_cselect_b32 s49, 0, s49
    buffer_load_dwordx4 v[104:107], v113, s[24:27], s48 offen
    buffer_load_dwordx4 v[108:111], v113, s[24:27], s48 offen offset:256
    s_waitcnt lgkmcnt(0)
    s_waitcnt vmcnt(6)
    v_mfma_f32_16x16x32_bf16 v[0:3], v[40:43], v[80:83], v[0:3]
    v_mfma_f32_16x16x32_bf16 v[20:23], v[40:43], v[84:87], v[20:23]
    ds_read_b128 v[60:63], v114 offset:46080
    v_mfma_f32_16x16x32_bf16 v[4:7], v[44:47], v[80:83], v[4:7]
    v_mfma_f32_16x16x32_bf16 v[24:27], v[44:47], v[84:87], v[24:27]
    ds_read_b128 v[64:67], v114 offset:47104
    v_mfma_f32_16x16x32_bf16 v[8:11], v[48:51], v[80:83], v[8:11]
    v_mfma_f32_16x16x32_bf16 v[28:31], v[48:51], v[84:87], v[28:31]
    ds_read_b128 v[68:71], v114 offset:48128
    v_mfma_f32_16x16x32_bf16 v[12:15], v[52:55], v[80:83], v[12:15]
    v_mfma_f32_16x16x32_bf16 v[32:35], v[52:55], v[84:87], v[32:35]
    ds_read_b128 v[72:75], v114 offset:49152
    v_mfma_f32_16x16x32_bf16 v[16:19], v[56:59], v[80:83], v[16:19]
    v_mfma_f32_16x16x32_bf16 v[36:39], v[56:59], v[84:87], v[36:39]
    ds_read_b128 v[76:79], v114 offset:50176
    s_add_u32 s48, s47, s49
    s_add_u32 s49, s49, 2048
    s_cmp_eq_u32 s49, 40960
    s_cselect_b32 s49, 0, s49
    buffer_load_dwordx4 v[80:83], v113, s[24:27], s48 offen
    buffer_load_dwordx4 v[84:87], v113, s[24:27], s48 offen offset:256
    s_waitcnt lgkmcnt(0)
    s_waitcnt vmcnt(6)
    v_mfma_f32_16x16x32_bf16 v[0:3], v[60:63], v[88:91], v[0:3]
    v_mfma_f32_16x16x32_bf16 v[20:23], v[60:63], v[92:95], v[20:23]
    ds_read_b128 v[40:43], v115 offset:0
    v_mfma_f32_16x16x32_bf16 v[4:7], v[64:67], v[88:91], v[4:7]
    v_mfma_f32_16x16x32_bf16 v[24:27], v[64:67], v[92:95], v[24:27]
    ds_read_b128 v[44:47], v115 offset:1024
    v_mfma_f32_16x16x32_bf16 v[8:11], v[68:71], v[88:91], v[8:11]
    v_mfma_f32_16x16x32_bf16 v[28:31], v[68:71], v[92:95], v[28:31]
    ds_read_b128 v[48:51], v115 offset:2048
    v_mfma_f32_16x16x32_bf16 v[12:15], v[72:75], v[88:91], v[12:15]
    v_mfma_f32_16x16x32_bf16 v[32:35], v[72:75], v[92:95], v[32:35]
    ds_read_b128 v[52:55], v115 offset:3072
    v_mfma_f32_16x16x32_bf16 v[16:19], v[76:79], v[88:91], v[16:19]
    v_mfma_f32_16x16x32_bf16 v[36:39], v[76:79], v[92:95], v[36:39]
    ds_read_b128 v[56:59], v115 offset:4096
    s_add_u32 s48, s47, s49
    s_add_u32 s49, s49, 2048
    s_cmp_eq_u32 s49, 40960
    s_cselect_b32 s49, 0, s49
    buffer_load_dwordx4 v[88:91], v113, s[24:27], s48 offen
    buffer_load_dwordx4 v[92:95], v113, s[24:27], s48 offen offset:256
    s_waitcnt lgkmcnt(0)
    s_waitcnt vmcnt(6)
    v_mfma_f32_16x16x32_bf16 v[0:3], v[40:43], v[96:99], v[0:3]
    v_mfma_f32_16x16x32_bf16 v[20:23], v[40:43], v[100:103], v[20:23]
    ds_read_b128 v[60:63], v115 offset:5120
    v_mfma_f32_16x16x32_bf16 v[4:7], v[44:47], v[96:99], v[4:7]
    v_mfma_f32_16x16x32_bf16 v[24:27], v[44:47], v[100:103], v[24:27]
    ds_read_b128 v[64:67], v115 offset:6144
    v_mfma_f32_16x16x32_bf16 v[8:11], v[48:51], v[96:99], v[8:11]
    v_mfma_f32_16x16x32_bf16 v[28:31], v[48:51], v[100:103], v[28:31]
    ds_read_b128 v[68:71], v115 offset:7168
    v_mfma_f32_16x16x32_bf16 v[12:15], v[52:55], v[96:99], v[12:15]
    v_mfma_f32_16x16x32_bf16 v[32:35], v[52:55], v[100:103], v[32:35]
    ds_read_b128 v[72:75], v115 offset:8192
    v_mfma_f32_16x16x32_bf16 v[16:19], v[56:59], v[96:99], v[16:19]
    v_mfma_f32_16x16x32_bf16 v[36:39], v[56:59], v[100:103], v[36:39]
    ds_read_b128 v[76:79], v115 offset:9216
    s_add_u32 s48, s47, s49
    s_add_u32 s49, s49, 2048
    s_cmp_eq_u32 s49, 40960
    s_cselect_b32 s49, 0, s49
    buffer_load_dwordx4 v[96:99], v113, s[24:27], s48 offen
    buffer_load_dwordx4 v[100:103], v113, s[24:27], s48 offen offset:256
    s_waitcnt lgkmcnt(0)
    s_barrier
    s_waitcnt vmcnt(6)
    v_mfma_f32_16x16x32_bf16 v[0:3], v[60:63], v[104:107], v[0:3]
    v_mfma_f32_16x16x32_bf16 v[20:23], v[60:63], v[108:111], v[20:23]
    ds_read_b128 v[40:43], v115 offset:10240
    v_mfma_f32_16x16x32_bf16 v[4:7], v[64:67], v[104:107], v[4:7]
    v_mfma_f32_16x16x32_bf16 v[24:27], v[64:67], v[108:111], v[24:27]
    ds_read_b128 v[44:47], v115 offset:11264
    v_mfma_f32_16x16x32_bf16 v[8:11], v[68:71], v[104:107], v[8:11]
    v_mfma_f32_16x16x32_bf16 v[28:31], v[68:71], v[108:111], v[28:31]
    ds_read_b128 v[48:51], v115 offset:12288
    v_mfma_f32_16x16x32_bf16 v[12:15], v[72:75], v[104:107], v[12:15]
    v_mfma_f32_16x16x32_bf16 v[32:35], v[72:75], v[108:111], v[32:35]
    ds_read_b128 v[52:55], v115 offset:13312
    v_mfma_f32_16x16x32_bf16 v[16:19], v[76:79], v[104:107], v[16:19]
    v_mfma_f32_16x16x32_bf16 v[36:39], v[76:79], v[108:111], v[36:39]
    ds_read_b128 v[56:59], v115 offset:14336
    s_add_u32 s48, s47, s49
    s_add_u32 s49, s49, 2048
    s_cmp_eq_u32 s49, 40960
    s_cselect_b32 s49, 0, s49
    buffer_load_dwordx4 v[104:107], v113, s[24:27], s48 offen
    buffer_load_dwordx4 v[108:111], v113, s[24:27], s48 offen offset:256
    s_waitcnt lgkmcnt(0)
    s_waitcnt vmcnt(6)
    v_mfma_f32_16x16x32_bf16 v[0:3], v[40:43], v[80:83], v[0:3]
    v_mfma_f32_16x16x32_bf16 v[20:23], v[40:43], v[84:87], v[20:23]
    ds_read_b128 v[60:63], v115 offset:15360
    v_mfma_f32_16x16x32_bf16 v[4:7], v[44:47], v[80:83], v[4:7]
    v_mfma_f32_16x16x32_bf16 v[24:27], v[44:47], v[84:87], v[24:27]
    ds_read_b128 v[64:67], v115 offset:16384
    v_mfma_f32_16x16x32_bf16 v[8:11], v[48:51], v[80:83], v[8:11]
    v_mfma_f32_16x16x32_bf16 v[28:31], v[48:51], v[84:87], v[28:31]
    ds_read_b128 v[68:71], v115 offset:17408
    v_mfma_f32_16x16x32_bf16 v[12:15], v[52:55], v[80:83], v[12:15]
    v_mfma_f32_16x16x32_bf16 v[32:35], v[52:55], v[84:87], v[32:35]
    ds_read_b128 v[72:75], v115 offset:18432
    v_mfma_f32_16x16x32_bf16 v[16:19], v[56:59], v[80:83], v[16:19]
    v_mfma_f32_16x16x32_bf16 v[36:39], v[56:59], v[84:87], v[36:39]
    ds_read_b128 v[76:79], v115 offset:19456
    s_add_u32 s48, s47, s49
    s_add_u32 s49, s49, 2048
    s_cmp_eq_u32 s49, 40960
    s_cselect_b32 s49, 0, s49
    buffer_load_dwordx4 v[80:83], v113, s[24:27], s48 offen
    buffer_load_dwordx4 v[84:87], v113, s[24:27], s48 offen offset:256
    s_waitcnt lgkmcnt(0)
    s_waitcnt vmcnt(6)
    v_mfma_f32_16x16x32_bf16 v[0:3], v[60:63], v[88:91], v[0:3]
    v_mfma_f32_16x16x32_bf16 v[20:23], v[60:63], v[92:95], v[20:23]
    ds_read_b128 v[40:43], v115 offset:20480
    v_mfma_f32_16x16x32_bf16 v[4:7], v[64:67], v[88:91], v[4:7]
    v_mfma_f32_16x16x32_bf16 v[24:27], v[64:67], v[92:95], v[24:27]
    ds_read_b128 v[44:47], v115 offset:21504
    v_mfma_f32_16x16x32_bf16 v[8:11], v[68:71], v[88:91], v[8:11]
    v_mfma_f32_16x16x32_bf16 v[28:31], v[68:71], v[92:95], v[28:31]
    ds_read_b128 v[48:51], v115 offset:22528
    v_mfma_f32_16x16x32_bf16 v[12:15], v[72:75], v[88:91], v[12:15]
    v_mfma_f32_16x16x32_bf16 v[32:35], v[72:75], v[92:95], v[32:35]
    ds_read_b128 v[52:55], v115 offset:23552
    v_mfma_f32_16x16x32_bf16 v[16:19], v[76:79], v[88:91], v[16:19]
    v_mfma_f32_16x16x32_bf16 v[36:39], v[76:79], v[92:95], v[36:39]
    ds_read_b128 v[56:59], v115 offset:24576
    s_add_u32 s48, s47, s49
    s_add_u32 s49, s49, 2048
    s_cmp_eq_u32 s49, 40960
    s_cselect_b32 s49, 0, s49
    buffer_load_dwordx4 v[88:91], v113, s[24:27], s48 offen
    buffer_load_dwordx4 v[92:95], v113, s[24:27], s48 offen offset:256
    s_waitcnt lgkmcnt(0)
    s_waitcnt vmcnt(6)
    v_mfma_f32_16x16x32_bf16 v[0:3], v[40:43], v[96:99], v[0:3]
    v_mfma_f32_16x16x32_bf16 v[20:23], v[40:43], v[100:103], v[20:23]
    ds_read_b128 v[60:63], v115 offset:25600
    v_mfma_f32_16x16x32_bf16 v[4:7], v[44:47], v[96:99], v[4:7]
    v_mfma_f32_16x16x32_bf16 v[24:27], v[44:47], v[100:103], v[24:27]
    ds_read_b128 v[64:67], v115 offset:26624
    v_mfma_f32_16x16x32_bf16 v[8:11], v[48:51], v[96:99], v[8:11]
    v_mfma_f32_16x16x32_bf16 v[28:31], v[48:51], v[100:103], v[28:31]
    ds_read_b128 v[68:71], v115 offset:27648
    v_mfma_f32_16x16x32_bf16 v[12:15], v[52:55], v[96:99], v[12:15]
    v_mfma_f32_16x16x32_bf16 v[32:35], v[52:55], v[100:103], v[32:35]
    ds_read_b128 v[72:75], v115 offset:28672
    v_mfma_f32_16x16x32_bf16 v[16:19], v[56:59], v[96:99], v[16:19]
    v_mfma_f32_16x16x32_bf16 v[36:39], v[56:59], v[100:103], v[36:39]
    ds_read_b128 v[76:79], v115 offset:29696
    s_add_u32 s48, s47, s49
    s_add_u32 s49, s49, 2048
    s_cmp_eq_u32 s49, 40960
    s_cselect_b32 s49, 0, s49
    buffer_load_dwordx4 v[96:99], v113, s[24:27], s48 offen
    buffer_load_dwordx4 v[100:103], v113, s[24:27], s48 offen offset:256
    s_waitcnt lgkmcnt(0)
    s_barrier
    s_waitcnt vmcnt(6)
    v_mfma_f32_16x16x32_bf16 v[0:3], v[60:63], v[104:107], v[0:3]
    v_mfma_f32_16x16x32_bf16 v[20:23], v[60:63], v[108:111], v[20:23]
    ds_read_b128 v[40:43], v115 offset:30720
    v_mfma_f32_16x16x32_bf16 v[4:7], v[64:67], v[104:107], v[4:7]
    v_mfma_f32_16x16x32_bf16 v[24:27], v[64:67], v[108:111], v[24:27]
    ds_read_b128 v[44:47], v115 offset:31744
    v_mfma_f32_16x16x32_bf16 v[8:11], v[68:71], v[104:107], v[8:11]
    v_mfma_f32_16x16x32_bf16 v[28:31], v[68:71], v[108:111], v[28:31]
    ds_read_b128 v[48:51], v115 offset:32768
    v_mfma_f32_16x16x32_bf16 v[12:15], v[72:75], v[104:107], v[12:15]
    v_mfma_f32_16x16x32_bf16 v[32:35], v[72:75], v[108:111], v[32:35]
    ds_read_b128 v[52:55], v115 offset:33792
    v_mfma_f32_16x16x32_bf16 v[16:19], v[76:79], v[104:107], v[16:19]
    v_mfma_f32_16x16x32_bf16 v[36:39], v[76:79], v[108:111], v[36:39]
    ds_read_b128 v[56:59], v115 offset:34816
    s_add_u32 s48, s47, s49
    s_add_u32 s49, s49, 2048
    s_cmp_eq_u32 s49, 40960
    s_cselect_b32 s49, 0, s49
    buffer_load_dwordx4 v[104:107], v113, s[24:27], s48 offen
    buffer_load_dwordx4 v[108:111], v113, s[24:27], s48 offen offset:256
    s_waitcnt lgkmcnt(0)
    s_waitcnt vmcnt(6)
    v_mfma_f32_16x16x32_bf16 v[0:3], v[40:43], v[80:83], v[0:3]
    v_mfma_f32_16x16x32_bf16 v[20:23], v[40:43], v[84:87], v[20:23]
    ds_read_b128 v[60:63], v115 offset:35840
    v_mfma_f32_16x16x32_bf16 v[4:7], v[44:47], v[80:83], v[4:7]
    v_mfma_f32_16x16x32_bf16 v[24:27], v[44:47], v[84:87], v[24:27]
    ds_read_b128 v[64:67], v115 offset:36864
    v_mfma_f32_16x16x32_bf16 v[8:11], v[48:51], v[80:83], v[8:11]
    v_mfma_f32_16x16x32_bf16 v[28:31], v[48:51], v[84:87], v[28:31]
    ds_read_b128 v[68:71], v115 offset:37888
    v_mfma_f32_16x16x32_bf16 v[12:15], v[52:55], v[80:83], v[12:15]
    v_mfma_f32_16x16x32_bf16 v[32:35], v[52:55], v[84:87], v[32:35]
    ds_read_b128 v[72:75], v115 offset:38912
    v_mfma_f32_16x16x32_bf16 v[16:19], v[56:59], v[80:83], v[16:19]
    v_mfma_f32_16x16x32_bf16 v[36:39], v[56:59], v[84:87], v[36:39]
    ds_read_b128 v[76:79], v115 offset:39936
    s_waitcnt lgkmcnt(0)
    s_waitcnt vmcnt(4)
    v_mfma_f32_16x16x32_bf16 v[0:3], v[60:63], v[88:91], v[0:3]
    v_mfma_f32_16x16x32_bf16 v[20:23], v[60:63], v[92:95], v[20:23]
    ds_read_b128 v[40:43], v115 offset:40960
    v_mfma_f32_16x16x32_bf16 v[4:7], v[64:67], v[88:91], v[4:7]
    v_mfma_f32_16x16x32_bf16 v[24:27], v[64:67], v[92:95], v[24:27]
    ds_read_b128 v[44:47], v115 offset:41984
    v_mfma_f32_16x16x32_bf16 v[8:11], v[68:71], v[88:91], v[8:11]
    v_mfma_f32_16x16x32_bf16 v[28:31], v[68:71], v[92:95], v[28:31]
    ds_read_b128 v[48:51], v115 offset:43008
    v_mfma_f32_16x16x32_bf16 v[12:15], v[72:75], v[88:91], v[12:15]
    v_mfma_f32_16x16x32_bf16 v[32:35], v[72:75], v[92:95], v[32:35]
    ds_read_b128 v[52:55], v115 offset:44032
    v_mfma_f32_16x16x32_bf16 v[16:19], v[76:79], v[88:91], v[16:19]
    v_mfma_f32_16x16x32_bf16 v[36:39], v[76:79], v[92:95], v[36:39]
    ds_read_b128 v[56:59], v115 offset:45056
    s_waitcnt lgkmcnt(0)
    s_waitcnt vmcnt(2)
    v_mfma_f32_16x16x32_bf16 v[0:3], v[40:43], v[96:99], v[0:3]
    v_mfma_f32_16x16x32_bf16 v[20:23], v[40:43], v[100:103], v[20:23]
    ds_read_b128 v[60:63], v115 offset:46080
    v_mfma_f32_16x16x32_bf16 v[4:7], v[44:47], v[96:99], v[4:7]
    v_mfma_f32_16x16x32_bf16 v[24:27], v[44:47], v[100:103], v[24:27]
    ds_read_b128 v[64:67], v115 offset:47104
    v_mfma_f32_16x16x32_bf16 v[8:11], v[48:51], v[96:99], v[8:11]
    v_mfma_f32_16x16x32_bf16 v[28:31], v[48:51], v[100:103], v[28:31]
    ds_read_b128 v[68:71], v115 offset:48128
    v_mfma_f32_16x16x32_bf16 v[12:15], v[52:55], v[96:99], v[12:15]
    v_mfma_f32_16x16x32_bf16 v[32:35], v[52:55], v[100:103], v[32:35]
    ds_read_b128 v[72:75], v115 offset:49152
    v_mfma_f32_16x16x32_bf16 v[16:19], v[56:59], v[96:99], v[16:19]
    v_mfma_f32_16x16x32_bf16 v[36:39], v[56:59], v[100:103], v[36:39]
    ds_read_b128 v[76:79], v115 offset:50176
    s_waitcnt lgkmcnt(0)
    s_waitcnt vmcnt(0)
    v_mfma_f32_16x16x32_bf16 v[0:3], v[60:63], v[104:107], v[0:3]
    v_mfma_f32_16x16x32_bf16 v[20:23], v[60:63], v[108:111], v[20:23]
    v_mfma_f32_16x16x32_bf16 v[4:7], v[64:67], v[104:107], v[4:7]
    v_mfma_f32_16x16x32_bf16 v[24:27], v[64:67], v[108:111], v[24:27]
    v_mfma_f32_16x16x32_bf16 v[8:11], v[68:71], v[104:107], v[8:11]
    v_mfma_f32_16x16x32_bf16 v[28:31], v[68:71], v[108:111], v[28:31]
    v_mfma_f32_16x16x32_bf16 v[12:15], v[72:75], v[104:107], v[12:15]
    v_mfma_f32_16x16x32_bf16 v[32:35], v[72:75], v[108:111], v[32:35]
    v_mfma_f32_16x16x32_bf16 v[16:19], v[76:79], v[104:107], v[16:19]
    v_mfma_f32_16x16x32_bf16 v[36:39], v[76:79], v[108:111], v[36:39]
    s_nop 7
    s_mov_b32 s52, s16
    s_and_b32 s53, s17, 0xffff
    s_mov_b32 s54, 5242880
    s_mov_b32 s55, 0x20000
    s_mul_i32 s49, s11, 5120
    s_add_u32 s49, s49, 102400
    v_and_b32 v64, 15, v112
    v_lshrrev_b32 v65, 4, v112
    v_mul_u32_u24 v66, 160, v64
    v_lshl_add_u32 v66, v65, 3, v66
    v_add_u32 v66, s49, v66
    s_lshl_b32 s50, s46, 5
    s_mul_i32 s50, s50, 2560
    s_mul_i32 s51, s5, 1280
    s_add_u32 s50, s50, s51
    s_mul_i32 s51, s9, 160
    s_add_u32 s50, s50, s51
    v_lshlrev_b32 v67, 4, v112
    v_add_u32 v67, s49, v67
    s_movk_i32 s51, 6554

    v_add_u32 v68, 0, v112
    v_mul_lo_u32 v69, v68, s51
    v_lshrrev_b32 v69, 16, v69
    v_mul_u32_u24 v70, 10, v69
    v_sub_u32 v70, v68, v70
    v_mul_u32_u24 v69, 2560, v69
    v_lshl_add_u32 v72, v70, 4, v69
    v_add_u32 v68, 64, v112
    v_mul_lo_u32 v69, v68, s51
    v_lshrrev_b32 v69, 16, v69
    v_mul_u32_u24 v70, 10, v69
    v_sub_u32 v70, v68, v70
    v_mul_u32_u24 v69, 2560, v69
    v_lshl_add_u32 v73, v70, 4, v69
    v_add_u32 v68, 128, v112
    v_mul_lo_u32 v69, v68, s51
    v_lshrrev_b32 v69, 16, v69
    v_mul_u32_u24 v70, 10, v69
    v_sub_u32 v70, v68, v70
    v_mul_u32_u24 v69, 2560, v69
    v_lshl_add_u32 v74, v70, 4, v69
    v_add_u32 v68, 192, v112
    v_mul_lo_u32 v69, v68, s51
    v_lshrrev_b32 v69, 16, v69
    v_mul_u32_u24 v70, 10, v69
    v_sub_u32 v70, v68, v70
    v_mul_u32_u24 v69, 2560, v69
    v_lshl_add_u32 v75, v70, 4, v69
    v_add_u32 v68, 256, v112
    v_mul_lo_u32 v69, v68, s51
    v_lshrrev_b32 v69, 16, v69
    v_mul_u32_u24 v70, 10, v69
    v_sub_u32 v70, v68, v70
    v_mul_u32_u24 v69, 2560, v69
    v_lshl_add_u32 v76, v70, 4, v69
    v_cvt_pk_bf16_f32 v80, v0, v1
    v_cvt_pk_bf16_f32 v81, v2, v3
    ds_write_b64 v66, v[80:81] offset:0
    v_cvt_pk_bf16_f32 v82, v4, v5
    v_cvt_pk_bf16_f32 v83, v6, v7
    ds_write_b64 v66, v[82:83] offset:32
    v_cvt_pk_bf16_f32 v84, v8, v9
    v_cvt_pk_bf16_f32 v85, v10, v11
    ds_write_b64 v66, v[84:85] offset:64
    v_cvt_pk_bf16_f32 v86, v12, v13
    v_cvt_pk_bf16_f32 v87, v14, v15
    ds_write_b64 v66, v[86:87] offset:96
    v_cvt_pk_bf16_f32 v88, v16, v17
    v_cvt_pk_bf16_f32 v89, v18, v19
    ds_write_b64 v66, v[88:89] offset:128
    v_cvt_pk_bf16_f32 v90, v20, v21
    v_cvt_pk_bf16_f32 v91, v22, v23
    ds_write_b64 v66, v[90:91] offset:2560
    v_cvt_pk_bf16_f32 v92, v24, v25
    v_cvt_pk_bf16_f32 v93, v26, v27
    ds_write_b64 v66, v[92:93] offset:2592
    v_cvt_pk_bf16_f32 v94, v28, v29
    v_cvt_pk_bf16_f32 v95, v30, v31
    ds_write_b64 v66, v[94:95] offset:2624
    v_cvt_pk_bf16_f32 v96, v32, v33
    v_cvt_pk_bf16_f32 v97, v34, v35
    ds_write_b64 v66, v[96:97] offset:2656
    v_cvt_pk_bf16_f32 v98, v36, v37
    v_cvt_pk_bf16_f32 v99, v38, v39
    ds_write_b64 v66, v[98:99] offset:2688
    s_waitcnt lgkmcnt(0)
    ds_read_b128 v[104:107], v67 offset:0
    ds_read_b128 v[108:111], v67 offset:1024
    ds_read_b128 v[112:115], v67 offset:2048
    ds_read_b128 v[116:119], v67 offset:3072
    ds_read_b128 v[120:123], v67 offset:4096
    s_waitcnt lgkmcnt(4)
    buffer_store_dwordx4 v[104:107], v72, s[52:55], s50 offen
    s_waitcnt lgkmcnt(3)
    buffer_store_dwordx4 v[108:111], v73, s[52:55], s50 offen
    s_waitcnt lgkmcnt(2)
    buffer_store_dwordx4 v[112:115], v74, s[52:55], s50 offen
    s_waitcnt lgkmcnt(1)
    buffer_store_dwordx4 v[116:119], v75, s[52:55], s50 offen
    s_waitcnt lgkmcnt(0)
    buffer_store_dwordx4 v[120:123], v76, s[52:55], s50 offen
K3_END:
    s_endpgm
.section .rodata,"a"
.p2align 6
.amdhsa_kernel k1_qkv_kernel
  .amdhsa_next_free_vgpr 192
  .amdhsa_next_free_sgpr 100
  .amdhsa_accum_offset 192
  .amdhsa_group_segment_fixed_size 0
  .amdhsa_kernarg_size 72
  .amdhsa_user_sgpr_count 2
  .amdhsa_user_sgpr_kernarg_segment_ptr 1
  .amdhsa_system_sgpr_workgroup_id_x 1
.end_amdhsa_kernel
.p2align 6
.amdhsa_kernel k2_attn_kernel
  .amdhsa_next_free_vgpr 128
  .amdhsa_next_free_sgpr 100
  .amdhsa_accum_offset 128
  .amdhsa_group_segment_fixed_size 0
  .amdhsa_kernarg_size 72
  .amdhsa_user_sgpr_count 2
  .amdhsa_user_sgpr_kernarg_segment_ptr 1
  .amdhsa_system_sgpr_workgroup_id_x 1
.end_amdhsa_kernel
.p2align 6
.amdhsa_kernel k3_proj_kernel
  .amdhsa_next_free_vgpr 148
  .amdhsa_next_free_sgpr 100
  .amdhsa_accum_offset 148
  .amdhsa_group_segment_fixed_size 0
  .amdhsa_kernarg_size 72
  .amdhsa_user_sgpr_count 2
  .amdhsa_user_sgpr_kernarg_segment_ptr 1
  .amdhsa_system_sgpr_workgroup_id_x 1
.end_amdhsa_kernel
```
